```python
import torch

def _softmax(x, axis=-1):
    return torch.softmax(x, dim=axis)
def _gelu(x):
    return torch.nn.functional.gelu(x, approximate="tanh")
def _silu(x):
    return torch.nn.functional.silu(x)
def _sigmoid(x):
    return torch.sigmoid(x)
def _layernorm(x, axis=-1, eps=1e-5):
    m = x.mean(dim=axis, keepdim=True)
    v = x.var(dim=axis, keepdim=True, unbiased=False)
    return (x - m) / torch.sqrt(v + eps)
def _scatter_add(tgt, idx, src, axis=0):
    return tgt.clone().index_add_(axis, idx, src)
def _segment_sum(src, seg, n):
    out = torch.zeros((n,) + src.shape[1:], dtype=src.dtype)
    return out.index_add_(0, seg, src)
def _pad(x, pw):
    flat = tuple(v for pair in reversed(pw) for v in pair)
    return torch.nn.functional.pad(x, flat)

kernel_name = 'gated_mix__gqa_block_cached__glu_gated_glu__decode'

def setup_inputs():

    _w = (lambda a: (lambda t: t.to(torch.bfloat16) if t.is_floating_point() else t)(torch.as_tensor(a)))
    def _A_setup():
        B, Sq, D = 4, 1, 512
        Hq, Hkv, Sk, Dh = 32, 8, 4096, 128
        assert Hq % Hkv == 0, (Hq, Hkv)
        return {
            "x": _w((lambda *s: torch.randn(*s, dtype=torch.bfloat16) * 0.05)(B, Sq, D)),
            "k_cache": _w((lambda *s: torch.randn(*s, dtype=torch.bfloat16) * 6.4)(B, Hkv, Sk, Dh)),
            "v_cache": _w((lambda *s: torch.randn(*s, dtype=torch.bfloat16) * 1.6)(B, Hkv, Sk, Dh)),
            "wq": _w((lambda *s: torch.randn(*s, dtype=torch.bfloat16) * 6.4)(D, Hq * Dh) * (D ** -0.5)),
            "wo": _w((lambda *s: torch.randn(*s, dtype=torch.bfloat16) * 1.6)(Hq * Dh, D) * ((Hq * Dh) ** -0.5)),
        }
    _A_in = _A_setup()

    def _B_setup():
        B, S, D, F = 4, 1, 512, 1792
        return {
            "x": _w((lambda *s: torch.randn(*s, dtype=torch.bfloat16) * 0.05)(B, S, D)),
            "w_gate": _w((lambda *s: torch.randn(*s, dtype=torch.bfloat16) * 3.2)(D, F)),
            "w_up": _w((lambda *s: torch.randn(*s, dtype=torch.bfloat16) * 0.1)(D, F)),
            "w_down": _w((lambda *s: torch.randn(*s, dtype=torch.bfloat16) * 0.1)(F, D)),
        }
    _B_in = _B_setup()

    return {
        "A_x": _A_in["x"],
        "A_k_cache": _A_in["k_cache"],
        "A_v_cache": _A_in["v_cache"],
        "A_wq": _A_in["wq"],
        "A_wo": _A_in["wo"],
        "B_x": _B_in["x"],
        "B_w_gate": _B_in["w_gate"],
        "B_w_up": _B_in["w_up"],
        "B_w_down": _B_in["w_down"],
        "gate_w": _w((lambda *s: torch.randn(*s, dtype=torch.bfloat16) * 0.05)(512) * 16.0),
    }

def reference(A_x, A_k_cache, A_v_cache, A_wq, A_wo, B_x, B_w_gate, B_w_up, B_w_down, gate_w):
    def _A_ref(x, k_cache, v_cache, wq, wo):
        B, Sq, D = x.shape
        Hq, Dh = 32, 128
        Hkv = k_cache.shape[1]
        rep = Hq // Hkv
        q = (lambda x, *d: x.permute(*d))((x @ wq).reshape(B, Sq, Hq, Dh), 0, 2, 1, 3)
        k = (lambda x, n, axis: torch.repeat_interleave(x, n, dim=axis))(k_cache, rep, axis=1)
        v = (lambda x, n, axis: torch.repeat_interleave(x, n, dim=axis))(v_cache, rep, axis=1)
        scores = torch.einsum("bhqd,bhkd->bhqk", q, k) * (Dh ** -0.5)
        p = _softmax(scores, axis=-1)
        o = torch.einsum("bhqk,bhkd->bhqd", p, v)
        return (lambda x, *d: x.permute(*d))(o, 0, 2, 1, 3).reshape(B, Sq, Hq * Dh) @ wo

    def _B_ref(x, w_gate, w_up, w_down):
        g = torch.einsum("bsd,df->bsf", x, w_gate)
        u = torch.einsum("bsd,df->bsf", x, w_up)
        h = _sigmoid(g) * u
        return torch.einsum("bsf,fd->bsd", h, w_down)

    x = A_x
    g = _sigmoid((x * gate_w).sum(-1, keepdims=True))
    a = _A_ref(x, A_k_cache, A_v_cache, A_wq, A_wo)
    b = _B_ref(x, B_w_gate, B_w_up, B_w_down)
    return g * a + (1 - g) * b
```

```asm
; @launch grid=(256,1,1) block=(512,1,1) lds=163840
.amdgcn_target "amdgcn-amd-amdhsa--gfx950"
.text
.globl gated_mix__gqa_block_cached__glu_gated_glu__decode_kernel
.p2align 8
.type gated_mix__gqa_block_cached__glu_gated_glu__decode_kernel,@function
gated_mix__gqa_block_cached__glu_gated_glu__decode_kernel:
  s_cmp_ge_u32 s2, 256
  s_cbranch_scc1 L_end
  s_load_dwordx16 s[64:79], s[0:1], 0
  s_load_dwordx8 s[80:87], s[0:1], 64
  s_load_dwordx2 s[88:89], s[0:1], 96
  v_and_b32 v1, 63, v0
  v_lshrrev_b32 v13, 6, v0
  v_lshrrev_b32 v2, 4, v1
  v_readfirstlane_b32 s52, v13
  v_and_b32 v3, 15, v1
  s_and_b32 s53, s2, 7
  s_lshr_b32 s54, s2, 3
  s_lshr_b32 s55, s54, 3
  s_and_b32 s56, s54, 7
  s_lshr_b32 s57, s54, 2
  s_and_b32 s58, s54, 3
  s_lshl_b32 s96, s55, 3
  s_add_u32 s96, s96, s53
  s_lshl_b32 s96, s96, 3
  s_add_u32 s96, s96, s56
  s_lshl_b32 s60, s96, 17
  s_lshl_b32 s97, s53, 3
  s_add_u32 s97, s97, s57
  s_mov_b32 s94, 0x3fb8aa3b
  s_mov_b32 s95, 0x3db504f3
  s_mov_b32 s61, 0x200000
  s_getreg_b32 s100, hwreg(HW_REG_XCC_ID, 0, 4)
  v_lshlrev_b32 v10, 4, v1
  v_and_b32 v15, 1, v1
  v_lshlrev_b32 v15, 4, v15
  v_lshrrev_b32 v16, 3, v1
  v_lshlrev_b32 v16, 13, v16
  v_and_b32 v14, 7, v1
  v_lshrrev_b32 v14, 1, v14
  v_xor_b32 v14, v14, v2
  v_lshl_add_u32 v16, v14, 5, v16
  v_add_u32 v16, v16, v15
  v_lshrrev_b32 v13, 3, v1
  v_mul_u32_u24 v17, 3584, v13
  v_lshl_add_u32 v17, v14, 5, v17
  v_add_u32 v17, v17, v15
  s_waitcnt lgkmcnt(0)
  s_load_dword s59, s[88:89], 0
  s_sub_u32 s3, s53, 1
  s_cmp_gt_u32 s53, 5
  s_cselect_b32 s74, s3, s53
  s_cmp_eq_u32 s53, 5
  s_cselect_b32 s74, 7, s74
  s_lshl_b32 s75, s74, 3
  s_add_u32 s75, s75, s57
  s_mov_b32 s8, s64
  s_mov_b32 s9, s65
  s_mov_b32 s10, 0x1000
  s_mov_b32 s11, 0x20000
  s_mov_b32 s20, s70
  s_mov_b32 s21, s71
  s_mov_b32 s22, 0x400000
  s_mov_b32 s23, 0x20000
  s_mov_b32 s28, s76
  s_mov_b32 s29, s77
  s_cmp_eq_u32 s74, 7
  s_cselect_b32 s30, 0, 0x1c0000
  s_mov_b32 s31, 0x20000
  s_mov_b32 s32, s78
  s_mov_b32 s33, s79
  s_cmp_eq_u32 s74, 7
  s_cselect_b32 s34, 0, 0x1c0000
  s_mov_b32 s35, 0x20000
  s_cmp_eq_u32 s52, 4
  s_cbranch_scc0 L_pre_rest
  s_mov_b32 m0, 0x24000
  s_lshl_b32 s90, s55, 20
  buffer_load_dwordx4 v10, s[8:11], 0 offen offset:0 lds
  buffer_load_dwordx4 v10, s[8:11], 0 offen offset:1024 lds
  buffer_load_dwordx4 v10, s[8:11], 0 offen offset:2048 lds
  buffer_load_dwordx4 v10, s[8:11], 0 offen offset:3072 lds
  s_lshl_b32 s3, s53, 10
  s_add_u32 s90, s90, s3
  s_lshl_b32 s3, s56, 7
  s_add_u32 s90, s90, s3
  s_mov_b32 m0, 0x20000
  s_add_u32 s91, s90, 0
  buffer_load_dwordx4 v16, s[20:23], s91 offen nt lds
  s_mov_b32 m0, 0x20400
  s_add_u32 s91, s90, 65536
  buffer_load_dwordx4 v16, s[20:23], s91 offen nt lds
  s_mov_b32 m0, 0x20800
  s_add_u32 s91, s90, 131072
  buffer_load_dwordx4 v16, s[20:23], s91 offen nt lds
  s_mov_b32 m0, 0x20c00
  s_add_u32 s91, s90, 196608
  buffer_load_dwordx4 v16, s[20:23], s91 offen nt lds
  s_mov_b32 m0, 0x21000
  s_add_u32 s91, s90, 262144
  buffer_load_dwordx4 v16, s[20:23], s91 offen nt lds
  s_mov_b32 m0, 0x21400
  s_add_u32 s91, s90, 327680
  buffer_load_dwordx4 v16, s[20:23], s91 offen nt lds
  s_mov_b32 m0, 0x21800
  s_add_u32 s91, s90, 393216
  buffer_load_dwordx4 v16, s[20:23], s91 offen nt lds
  s_mov_b32 m0, 0x21c00
  s_add_u32 s91, s90, 458752
  buffer_load_dwordx4 v16, s[20:23], s91 offen nt lds
  s_mov_b32 m0, 0x22000
  s_add_u32 s91, s90, 524288
  buffer_load_dwordx4 v16, s[20:23], s91 offen nt lds
  s_mov_b32 m0, 0x22400
  s_add_u32 s91, s90, 589824
  buffer_load_dwordx4 v16, s[20:23], s91 offen nt lds
  s_mov_b32 m0, 0x22800
  s_add_u32 s91, s90, 655360
  buffer_load_dwordx4 v16, s[20:23], s91 offen nt lds
  s_mov_b32 m0, 0x22c00
  s_add_u32 s91, s90, 720896
  buffer_load_dwordx4 v16, s[20:23], s91 offen nt lds
  s_mov_b32 m0, 0x23000
  s_add_u32 s91, s90, 786432
  buffer_load_dwordx4 v16, s[20:23], s91 offen nt lds
  s_mov_b32 m0, 0x23400
  s_add_u32 s91, s90, 851968
  buffer_load_dwordx4 v16, s[20:23], s91 offen nt lds
  s_mov_b32 m0, 0x23800
  s_add_u32 s91, s90, 917504
  buffer_load_dwordx4 v16, s[20:23], s91 offen nt lds
  s_mov_b32 m0, 0x23c00
  s_add_u32 s91, s90, 983040
  buffer_load_dwordx4 v16, s[20:23], s91 offen nt lds
  s_and_b32 s3, s75, 1
  s_lshl_b32 s3, s3, 2
  s_add_u32 s3, s3, s58
  s_mul_i32 s90, s3, 229376
  s_lshr_b32 s3, s75, 1
  s_lshl_b32 s3, s3, 7
  s_add_u32 s90, s90, s3
  s_mov_b32 m0, 0x18000
  s_add_u32 s91, s90, 0
  buffer_load_dwordx4 v17, s[28:31], s91 offen nt lds
  s_mov_b32 m0, 0x1a000
  s_add_u32 s91, s90, 0
  buffer_load_dwordx4 v17, s[32:35], s91 offen nt lds
  s_mov_b32 m0, 0x18400
  s_add_u32 s91, s90, 28672
  buffer_load_dwordx4 v17, s[28:31], s91 offen nt lds
  s_mov_b32 m0, 0x1a400
  s_add_u32 s91, s90, 28672
  buffer_load_dwordx4 v17, s[32:35], s91 offen nt lds
  s_mov_b32 m0, 0x18800
  s_add_u32 s91, s90, 57344
  buffer_load_dwordx4 v17, s[28:31], s91 offen nt lds
  s_mov_b32 m0, 0x1a800
  s_add_u32 s91, s90, 57344
  buffer_load_dwordx4 v17, s[32:35], s91 offen nt lds
  s_mov_b32 m0, 0x18c00
  s_add_u32 s91, s90, 86016
  buffer_load_dwordx4 v17, s[28:31], s91 offen nt lds
  s_mov_b32 m0, 0x1ac00
  s_add_u32 s91, s90, 86016
  buffer_load_dwordx4 v17, s[32:35], s91 offen nt lds
  s_mov_b32 m0, 0x19000
  s_add_u32 s91, s90, 114688
  buffer_load_dwordx4 v17, s[28:31], s91 offen nt lds
  s_mov_b32 m0, 0x1b000
  s_add_u32 s91, s90, 114688
  buffer_load_dwordx4 v17, s[32:35], s91 offen nt lds
  s_mov_b32 m0, 0x19400
  s_add_u32 s91, s90, 143360
  buffer_load_dwordx4 v17, s[28:31], s91 offen nt lds
  s_mov_b32 m0, 0x1b400
  s_add_u32 s91, s90, 143360
  buffer_load_dwordx4 v17, s[32:35], s91 offen nt lds
  s_mov_b32 m0, 0x19800
  s_add_u32 s91, s90, 172032
  buffer_load_dwordx4 v17, s[28:31], s91 offen nt lds
  s_mov_b32 m0, 0x1b800
  s_add_u32 s91, s90, 172032
  buffer_load_dwordx4 v17, s[32:35], s91 offen nt lds
  s_mov_b32 m0, 0x19c00
  s_add_u32 s91, s90, 200704
  buffer_load_dwordx4 v17, s[28:31], s91 offen nt lds
  s_mov_b32 m0, 0x1bc00
  s_add_u32 s91, s90, 200704
  buffer_load_dwordx4 v17, s[32:35], s91 offen nt lds
L_pre_rest:
  s_mov_b32 s12, s66
  s_mov_b32 s13, s67
  s_mov_b32 s14, 0x2000000
  s_mov_b32 s15, 0x20000
  s_mov_b32 s16, s68
  s_mov_b32 s17, s69
  s_mov_b32 s18, 0x2000000
  s_mov_b32 s19, 0x20000
  s_mov_b32 s36, s80
  s_mov_b32 s37, s81
  s_cmp_eq_u32 s74, 7
  s_cselect_b32 s38, 0, 0x1c0000
  s_mov_b32 s39, 0x20000
  s_mov_b32 s24, s72
  s_mov_b32 s25, s73
  s_mov_b32 s26, 0x400000
  s_mov_b32 s27, 0x20000
  s_mov_b32 s40, s82
  s_mov_b32 s41, s83
  s_mov_b32 s42, 0x400
  s_mov_b32 s43, 0x20000
  s_mov_b32 s44, s84
  s_mov_b32 s45, s85
  s_mov_b32 s46, 0x1000
  s_mov_b32 s47, 0x20000
  s_mov_b32 s48, s88
  s_mov_b32 s49, s89
  s_mov_b32 s50, 0x10000000
  s_mov_b32 s51, 0x20000
  v_lshlrev_b32 v13, 2, v1
  v_add_u32 v13, 0x27600, v13
  v_mov_b32 v14, 0
  s_mov_b32 exec_hi, 0
  ds_write_b32 v13, v14
  s_mov_b64 exec, -1
  v_mov_b32 v56, 0
  s_waitcnt lgkmcnt(0)
  s_mul_i32 s88, s2, 17
  s_and_b32 s88, s88, 127
  s_lshr_b32 s89, s88, 3
  s_add_u32 s89, s89, 1
  v_lshrrev_b32 v13, 2, v3
  v_lshlrev_b32 v4, 8, v13
  v_and_b32 v13, 3, v3
  v_lshl_add_u32 v4, v13, 6, v4
  v_lshl_add_u32 v4, v2, 4, v4
  s_add_u32 s92, s88, s52
  s_lshl_b32 s92, s92, 10
L_b0:
  s_barrier
  s_cmp_lt_u32 s52, 4
  s_cbranch_scc0 L_notC
  s_and_b32 s91, s92, 0x1ffff
  s_add_u32 s90, s91, s60
  s_add_u32 s92, s92, 4096
  buffer_load_dwordx4 v[64:67], v4, s[12:15], s90 offen nt
  s_and_b32 s91, s92, 0x1ffff
  s_add_u32 s90, s91, s60
  s_add_u32 s92, s92, 4096
  buffer_load_dwordx4 v[68:71], v4, s[12:15], s90 offen nt
  s_and_b32 s91, s92, 0x1ffff
  s_add_u32 s90, s91, s60
  s_add_u32 s92, s92, 4096
  buffer_load_dwordx4 v[72:75], v4, s[12:15], s90 offen nt
  s_and_b32 s91, s92, 0x1ffff
  s_add_u32 s90, s91, s60
  s_add_u32 s92, s92, 4096
  buffer_load_dwordx4 v[76:79], v4, s[12:15], s90 offen nt
  s_and_b32 s91, s92, 0x1ffff
  s_add_u32 s90, s91, s60
  s_add_u32 s92, s92, 4096
  buffer_load_dwordx4 v[80:83], v4, s[12:15], s90 offen nt
  s_and_b32 s91, s92, 0x1ffff
  s_add_u32 s90, s91, s60
  s_add_u32 s92, s92, 4096
  buffer_load_dwordx4 v[84:87], v4, s[12:15], s90 offen nt
  s_and_b32 s91, s92, 0x1ffff
  s_add_u32 s90, s91, s60
  s_add_u32 s92, s92, 4096
  buffer_load_dwordx4 v[88:91], v4, s[12:15], s90 offen nt
  s_and_b32 s91, s92, 0x1ffff
  s_add_u32 s90, s91, s60
  s_add_u32 s92, s92, 4096
  buffer_load_dwordx4 v[92:95], v4, s[12:15], s90 offen nt
  s_and_b32 s91, s92, 0x1ffff
  s_add_u32 s90, s91, s60
  s_add_u32 s92, s92, 4096
  buffer_load_dwordx4 v[96:99], v4, s[12:15], s90 offen nt
  s_and_b32 s91, s92, 0x1ffff
  s_add_u32 s90, s91, s60
  s_add_u32 s92, s92, 4096
  buffer_load_dwordx4 v[100:103], v4, s[12:15], s90 offen nt
  s_and_b32 s91, s92, 0x1ffff
  s_add_u32 s90, s91, s60
  s_add_u32 s92, s92, 4096
  buffer_load_dwordx4 v[104:107], v4, s[12:15], s90 offen nt
  s_and_b32 s91, s92, 0x1ffff
  s_add_u32 s90, s91, s60
  s_add_u32 s92, s92, 4096
  buffer_load_dwordx4 v[108:111], v4, s[12:15], s90 offen nt
  s_and_b32 s91, s92, 0x1ffff
  s_add_u32 s90, s91, s60
  s_add_u32 s92, s92, 4096
  buffer_load_dwordx4 v[112:115], v4, s[12:15], s90 offen nt
  s_and_b32 s91, s92, 0x1ffff
  s_add_u32 s90, s91, s60
  s_add_u32 s92, s92, 4096
  buffer_load_dwordx4 v[116:119], v4, s[12:15], s90 offen nt
  s_and_b32 s91, s92, 0x1ffff
  s_add_u32 s90, s91, s60
  s_add_u32 s92, s92, 4096
  buffer_load_dwordx4 v[120:123], v4, s[12:15], s90 offen nt
  s_and_b32 s91, s92, 0x1ffff
  s_add_u32 s90, s91, s60
  s_add_u32 s92, s92, 4096
  buffer_load_dwordx4 v[124:127], v4, s[12:15], s90 offen nt
  s_and_b32 s91, s92, 0x1ffff
  s_add_u32 s90, s91, s60
  s_add_u32 s92, s92, 4096
  buffer_load_dwordx4 v[128:131], v4, s[12:15], s90 offen nt
  s_and_b32 s91, s92, 0x1ffff
  s_add_u32 s90, s91, s60
  s_add_u32 s92, s92, 4096
  buffer_load_dwordx4 v[132:135], v4, s[12:15], s90 offen nt
  s_and_b32 s91, s92, 0x1ffff
  s_add_u32 s90, s91, s60
  s_add_u32 s92, s92, 4096
  buffer_load_dwordx4 v[136:139], v4, s[12:15], s90 offen nt
  s_and_b32 s91, s92, 0x1ffff
  s_add_u32 s90, s91, s60
  s_add_u32 s92, s92, 4096
  buffer_load_dwordx4 v[140:143], v4, s[12:15], s90 offen nt
  s_and_b32 s91, s92, 0x1ffff
  s_add_u32 s90, s91, s60
  s_add_u32 s92, s92, 4096
  buffer_load_dwordx4 v[144:147], v4, s[12:15], s90 offen nt
  s_and_b32 s91, s92, 0x1ffff
  s_add_u32 s90, s91, s60
  s_add_u32 s92, s92, 4096
  buffer_load_dwordx4 v[148:151], v4, s[12:15], s90 offen nt
  s_and_b32 s91, s92, 0x1ffff
  s_add_u32 s90, s91, s60
  s_add_u32 s92, s92, 4096
  buffer_load_dwordx4 v[152:155], v4, s[12:15], s90 offen nt
  s_and_b32 s91, s92, 0x1ffff
  s_add_u32 s90, s91, s60
  s_add_u32 s92, s92, 4096
  buffer_load_dwordx4 v[156:159], v4, s[12:15], s90 offen nt
  s_and_b32 s91, s92, 0x1ffff
  s_add_u32 s90, s91, s60
  s_add_u32 s92, s92, 4096
  buffer_load_dwordx4 v[160:163], v4, s[12:15], s90 offen nt
  s_and_b32 s91, s92, 0x1ffff
  s_add_u32 s90, s91, s60
  s_add_u32 s92, s92, 4096
  buffer_load_dwordx4 v[164:167], v4, s[12:15], s90 offen nt
  s_and_b32 s91, s92, 0x1ffff
  s_add_u32 s90, s91, s60
  s_add_u32 s92, s92, 4096
  buffer_load_dwordx4 v[168:171], v4, s[12:15], s90 offen nt
  s_and_b32 s91, s92, 0x1ffff
  s_add_u32 s90, s91, s60
  s_add_u32 s92, s92, 4096
  buffer_load_dwordx4 v[172:175], v4, s[12:15], s90 offen nt
  s_and_b32 s91, s92, 0x1ffff
  s_add_u32 s90, s91, s60
  s_add_u32 s92, s92, 4096
  buffer_load_dwordx4 v[176:179], v4, s[12:15], s90 offen nt
  s_and_b32 s91, s92, 0x1ffff
  s_add_u32 s90, s91, s60
  s_add_u32 s92, s92, 4096
  buffer_load_dwordx4 v[180:183], v4, s[12:15], s90 offen nt
  s_and_b32 s91, s92, 0x1ffff
  s_add_u32 s90, s91, s60
  s_add_u32 s92, s92, 4096
  buffer_load_dwordx4 v[184:187], v4, s[12:15], s90 offen nt
  s_and_b32 s91, s92, 0x1ffff
  s_add_u32 s90, s91, s60
  s_add_u32 s92, s92, 4096
  buffer_load_dwordx4 v[188:191], v4, s[12:15], s90 offen nt
L_notC:
  v_and_b32 v15, 1, v1
  v_lshlrev_b32 v15, 4, v15
  v_lshrrev_b32 v13, 1, v3
  v_xor_b32 v13, v13, v2
  v_xor_b32 v14, 4, v13
  v_lshl_add_u32 v13, v13, 5, v15
  v_lshl_add_u32 v14, v14, 5, v15
  v_lshl_add_u32 v7, v2, 10, v13
  v_lshl_add_u32 v8, v2, 10, v14
  v_and_b32 v13, 1, v2
  v_lshlrev_b32 v13, 2, v13
  v_lshrrev_b32 v14, 1, v3
  v_xor_b32 v13, v13, v14
  v_lshl_add_u32 v13, v13, 5, v15
  v_lshl_add_u32 v5, v2, 8, v13
  v_mov_b32 v0, v5
  s_add_u32 s3, s88, 0
  s_and_b32 s3, s3, 3
  s_lshl_b32 s3, s3, 5
  v_xor_b32 v5, s3, v0
  s_add_u32 s3, s88, 1
  s_and_b32 s3, s3, 3
  s_lshl_b32 s3, s3, 5
  v_xor_b32 v6, s3, v0
  s_add_u32 s3, s88, 2
  s_and_b32 s3, s3, 3
  s_lshl_b32 s3, s3, 5
  v_xor_b32 v11, s3, v0
  s_add_u32 s3, s88, 3
  s_and_b32 s3, s3, 3
  s_lshl_b32 s3, s3, 5
  v_xor_b32 v14, s3, v0
  v_mov_b32 v0, v14
  v_lshrrev_b32 v13, 2, v1
  v_and_b32 v14, 7, v13
  s_lshl_b32 s3, s52, 1
  s_and_b32 s3, s3, 7
  v_xor_b32 v14, s3, v14
  v_lshlrev_b32 v9, 8, v13
  v_lshl_add_u32 v9, v14, 5, v9
  v_and_b32 v15, 3, v1
  v_lshlrev_b32 v15, 3, v15
  v_add_u32 v9, v15, v9
  v_lshrrev_b32 v14, 2, v3
  v_lshl_add_u32 v12, v14, 2, v2
  v_lshlrev_b32 v12, 8, v12
  v_and_b32 v20, 1, v2
  v_lshl_add_u32 v14, v20, 2, v14
  v_xor_b32 v14, s52, v14
  v_lshl_add_u32 v12, v14, 5, v12
  v_add_u32 v12, v15, v12
  s_waitcnt lgkmcnt(0)
  s_add_u32 s59, s59, 1
  s_cmp_lt_u32 s52, 4
  s_cbranch_scc1 L_C
  s_cmp_eq_u32 s52, 4
  s_cbranch_scc0 L_A
  s_waitcnt vmcnt(16)
  v_mov_b32 v13, 0x27600
  v_mov_b32 v14, 1
  s_waitcnt lgkmcnt(0)
  ds_write_b32 v13, v14
  s_waitcnt vmcnt(0)
  v_mov_b32 v13, 0x27604
  v_mov_b32 v14, 1
  s_waitcnt lgkmcnt(0)
  ds_write_b32 v13, v14
  v_lshlrev_b32 v58, 6, v3
  v_lshl_add_u32 v58, v2, 4, v58
  s_lshl_b32 s4, s96, 11
  s_lshl_b32 s3, s52, 8
  s_add_u32 s4, s4, s3
  s_add_u32 s4, s4, 0x40000
  s_lshr_b32 s5, s52, 1
  s_lshl_b32 s5, s5, 3
  s_add_u32 s5, s5, s53
  s_lshl_b32 s5, s5, 3
  s_and_b32 s3, s52, 1
  s_lshl_b32 s3, s3, 2
  s_add_u32 s5, s5, s3
  s_lshl_b32 s5, s5, 11
  s_lshl_b32 s3, s57, 8
  s_add_u32 s5, s5, s3
  s_add_u32 s5, s5, 0x40000
  v_lshlrev_b32 v59, 11, v2
  v_lshl_add_u32 v59, v3, 4, v59
  v_lshrrev_b32 v13, 3, v3
  v_lshlrev_b32 v13, 2, v13
  v_and_b32 v14, 3, v3
  v_add_u32 v13, v13, v14
  s_and_b32 s3, s52, 1
  s_lshl_b32 s3, s3, 2
  v_add_u32 v14, s3, v2
  v_xor_b32 v13, v13, v14
  v_lshlrev_b32 v13, 4, v13
  v_lshrrev_b32 v14, 2, v3
  v_and_b32 v14, 1, v14
  v_lshl_add_u32 v13, v14, 3, v13
  v_lshl_add_u32 v13, v2, 7, v13
  s_lshl_b32 s3, s52, 9
  s_add_u32 s3, s3, 0x26000
  v_add_u32 v60, s3, v13
  v_lshrrev_b32 v13, 2, v3
  v_lshlrev_b32 v13, 2, v13
  v_lshl_add_u32 v13, v2, 4, v13
  s_lshl_b32 s3, s52, 6
  s_add_u32 s3, s3, 0x27800
  v_add_u32 v61, s3, v13
  v_and_b32 v14, 7, v3
  v_xor_b32 v54, v2, v14
  v_xor_b32 v55, 4, v54
  v_lshlrev_b32 v54, 4, v54
  v_lshlrev_b32 v55, 4, v55
  v_lshl_add_u32 v54, v3, 7, v54
  v_lshl_add_u32 v55, v3, 7, v55
  v_add_u32 v54, 0x26000, v54
  v_add_u32 v55, 0x26000, v55
  v_add_u32 v57, 0x20000, v9
  v_lshrrev_b32 v63, 1, v2
  v_lshlrev_b32 v63, 19, v63
  v_lshrrev_b32 v13, 3, v3
  v_lshl_add_u32 v63, v13, 13, v63
  v_and_b32 v13, 7, v3
  v_lshl_add_u32 v63, v13, 4, v63
  s_lshl_b32 s7, s58, 3
  s_lshl_b32 s3, s52, 1
  s_and_b32 s3, s3, 7
  s_add_u32 s7, s7, s3
  s_lshl_b32 s7, s7, 14
  s_lshl_b32 s3, s97, 7
  s_add_u32 s7, s7, s3
  s_add_u32 s7, s7, 0x100000
  s_add_u32 s6, s7, 16384
  v_mov_b32 v13, 0x27618
L_spin1:
  ds_read_b32 v24, v13
  s_waitcnt lgkmcnt(0)
  v_cmp_ne_u32 vcc, 1, v24
  s_cbranch_vccz L_spin1_ok
  s_sub_u32 s61, s61, 1
  s_cbranch_scc1 L_end
  s_sleep 1
  s_branch L_spin1
L_spin1_ok:
  s_lshl_b32 s90, s75, 15
  s_lshl_b32 s3, s58, 8
  s_add_u32 s90, s90, s3
  s_mov_b32 m0, 0x25000
  s_add_u32 s91, s90, 0
  buffer_load_dwordx4 v7, s[36:39], s91 offen nt lds
  s_mov_b32 m0, 0x25400
  s_add_u32 s91, s90, 4096
  buffer_load_dwordx4 v8, s[36:39], s91 offen nt lds
  s_mov_b32 m0, 0x25800
  s_add_u32 s91, s90, 8192
  buffer_load_dwordx4 v7, s[36:39], s91 offen nt lds
  s_mov_b32 m0, 0x25c00
  s_add_u32 s91, s90, 12288
  buffer_load_dwordx4 v8, s[36:39], s91 offen nt lds
  s_mov_b32 m0, 0x26000
  s_add_u32 s91, s90, 16384
  buffer_load_dwordx4 v7, s[36:39], s91 offen nt lds
  s_mov_b32 m0, 0x26400
  s_add_u32 s91, s90, 20480
  buffer_load_dwordx4 v8, s[36:39], s91 offen nt lds
  s_mov_b32 m0, 0x26800
  s_add_u32 s91, s90, 24576
  buffer_load_dwordx4 v7, s[36:39], s91 offen nt lds
  s_mov_b32 m0, 0x26c00
  s_add_u32 s91, s90, 28672
  buffer_load_dwordx4 v8, s[36:39], s91 offen nt lds
  s_lshl_b32 s92, s88, 10
  s_and_b32 s91, s92, 0x1ffff
  s_mov_b32 m0, s91
  s_add_u32 s90, s91, s60
  s_add_u32 s92, s92, 1024
  buffer_load_dwordx4 v5, s[16:19], s90 offen nt lds
  s_and_b32 s91, s92, 0x1ffff
  s_mov_b32 m0, s91
  s_add_u32 s90, s91, s60
  s_add_u32 s92, s92, 1024
  buffer_load_dwordx4 v6, s[16:19], s90 offen nt lds
  s_and_b32 s91, s92, 0x1ffff
  s_mov_b32 m0, s91
  s_add_u32 s90, s91, s60
  s_add_u32 s92, s92, 1024
  buffer_load_dwordx4 v11, s[16:19], s90 offen nt lds
  s_and_b32 s91, s92, 0x1ffff
  s_mov_b32 m0, s91
  s_add_u32 s90, s91, s60
  s_add_u32 s92, s92, 1024
  buffer_load_dwordx4 v0, s[16:19], s90 offen nt lds
  s_and_b32 s91, s92, 0x1ffff
  s_mov_b32 m0, s91
  s_add_u32 s90, s91, s60
  s_add_u32 s92, s92, 1024
  buffer_load_dwordx4 v5, s[16:19], s90 offen nt lds
  s_and_b32 s91, s92, 0x1ffff
  s_mov_b32 m0, s91
  s_add_u32 s90, s91, s60
  s_add_u32 s92, s92, 1024
  buffer_load_dwordx4 v6, s[16:19], s90 offen nt lds
  s_and_b32 s91, s92, 0x1ffff
  s_mov_b32 m0, s91
  s_add_u32 s90, s91, s60
  s_add_u32 s92, s92, 1024
  buffer_load_dwordx4 v11, s[16:19], s90 offen nt lds
  s_and_b32 s91, s92, 0x1ffff
  s_mov_b32 m0, s91
  s_add_u32 s90, s91, s60
  s_add_u32 s92, s92, 1024
  buffer_load_dwordx4 v0, s[16:19], s90 offen nt lds
  s_and_b32 s91, s92, 0x1ffff
  s_mov_b32 m0, s91
  s_add_u32 s90, s91, s60
  s_add_u32 s92, s92, 1024
  buffer_load_dwordx4 v5, s[16:19], s90 offen nt lds
  s_and_b32 s91, s92, 0x1ffff
  s_mov_b32 m0, s91
  s_add_u32 s90, s91, s60
  s_add_u32 s92, s92, 1024
  buffer_load_dwordx4 v6, s[16:19], s90 offen nt lds
  s_and_b32 s91, s92, 0x1ffff
  s_mov_b32 m0, s91
  s_add_u32 s90, s91, s60
  s_add_u32 s92, s92, 1024
  buffer_load_dwordx4 v11, s[16:19], s90 offen nt lds
  s_and_b32 s91, s92, 0x1ffff
  s_mov_b32 m0, s91
  s_add_u32 s90, s91, s60
  s_add_u32 s92, s92, 1024
  buffer_load_dwordx4 v0, s[16:19], s90 offen nt lds
  s_and_b32 s91, s92, 0x1ffff
  s_mov_b32 m0, s91
  s_add_u32 s90, s91, s60
  s_add_u32 s92, s92, 1024
  buffer_load_dwordx4 v5, s[16:19], s90 offen nt lds
  s_and_b32 s91, s92, 0x1ffff
  s_mov_b32 m0, s91
  s_add_u32 s90, s91, s60
  s_add_u32 s92, s92, 1024
  buffer_load_dwordx4 v6, s[16:19], s90 offen nt lds
  s_and_b32 s91, s92, 0x1ffff
  s_mov_b32 m0, s91
  s_add_u32 s90, s91, s60
  s_add_u32 s92, s92, 1024
  buffer_load_dwordx4 v11, s[16:19], s90 offen nt lds
  s_and_b32 s91, s92, 0x1ffff
  s_mov_b32 m0, s91
  s_add_u32 s90, s91, s60
  s_add_u32 s92, s92, 1024
  buffer_load_dwordx4 v0, s[16:19], s90 offen nt lds
  s_and_b32 s91, s92, 0x1ffff
  s_mov_b32 m0, s91
  s_add_u32 s90, s91, s60
  s_add_u32 s92, s92, 1024
  buffer_load_dwordx4 v5, s[16:19], s90 offen nt lds
  s_and_b32 s91, s92, 0x1ffff
  s_mov_b32 m0, s91
  s_add_u32 s90, s91, s60
  s_add_u32 s92, s92, 1024
  buffer_load_dwordx4 v6, s[16:19], s90 offen nt lds
  s_and_b32 s91, s92, 0x1ffff
  s_mov_b32 m0, s91
  s_add_u32 s90, s91, s60
  s_add_u32 s92, s92, 1024
  buffer_load_dwordx4 v11, s[16:19], s90 offen nt lds
  s_and_b32 s91, s92, 0x1ffff
  s_mov_b32 m0, s91
  s_add_u32 s90, s91, s60
  s_add_u32 s92, s92, 1024
  buffer_load_dwordx4 v0, s[16:19], s90 offen nt lds
  s_and_b32 s91, s92, 0x1ffff
  s_mov_b32 m0, s91
  s_add_u32 s90, s91, s60
  s_add_u32 s92, s92, 1024
  buffer_load_dwordx4 v5, s[16:19], s90 offen nt lds
  s_and_b32 s91, s92, 0x1ffff
  s_mov_b32 m0, s91
  s_add_u32 s90, s91, s60
  s_add_u32 s92, s92, 1024
  buffer_load_dwordx4 v6, s[16:19], s90 offen nt lds
  s_and_b32 s91, s92, 0x1ffff
  s_mov_b32 m0, s91
  s_add_u32 s90, s91, s60
  s_add_u32 s92, s92, 1024
  buffer_load_dwordx4 v11, s[16:19], s90 offen nt lds
  s_and_b32 s91, s92, 0x1ffff
  s_mov_b32 m0, s91
  s_add_u32 s90, s91, s60
  s_add_u32 s92, s92, 1024
  buffer_load_dwordx4 v0, s[16:19], s90 offen nt lds
  s_and_b32 s91, s92, 0x1ffff
  s_mov_b32 m0, s91
  s_add_u32 s90, s91, s60
  s_add_u32 s92, s92, 1024
  buffer_load_dwordx4 v5, s[16:19], s90 offen nt lds
  s_and_b32 s91, s92, 0x1ffff
  s_mov_b32 m0, s91
  s_add_u32 s90, s91, s60
  s_add_u32 s92, s92, 1024
  buffer_load_dwordx4 v6, s[16:19], s90 offen nt lds
  s_and_b32 s91, s92, 0x1ffff
  s_mov_b32 m0, s91
  s_add_u32 s90, s91, s60
  s_add_u32 s92, s92, 1024
  buffer_load_dwordx4 v11, s[16:19], s90 offen nt lds
  s_and_b32 s91, s92, 0x1ffff
  s_mov_b32 m0, s91
  s_add_u32 s90, s91, s60
  s_add_u32 s92, s92, 1024
  buffer_load_dwordx4 v0, s[16:19], s90 offen nt lds
  s_and_b32 s91, s92, 0x1ffff
  s_mov_b32 m0, s91
  s_add_u32 s90, s91, s60
  s_add_u32 s92, s92, 1024
  buffer_load_dwordx4 v5, s[16:19], s90 offen nt lds
  s_and_b32 s91, s92, 0x1ffff
  s_mov_b32 m0, s91
  s_add_u32 s90, s91, s60
  s_add_u32 s92, s92, 1024
  buffer_load_dwordx4 v6, s[16:19], s90 offen nt lds
  s_and_b32 s91, s92, 0x1ffff
  s_mov_b32 m0, s91
  s_add_u32 s90, s91, s60
  s_add_u32 s92, s92, 1024
  buffer_load_dwordx4 v11, s[16:19], s90 offen nt lds
  s_and_b32 s91, s92, 0x1ffff
  s_mov_b32 m0, s91
  s_add_u32 s90, s91, s60
  s_add_u32 s92, s92, 1024
  buffer_load_dwordx4 v0, s[16:19], s90 offen nt lds
  s_and_b32 s91, s92, 0x1ffff
  s_mov_b32 m0, s91
  s_add_u32 s90, s91, s60
  s_add_u32 s92, s92, 1024
  buffer_load_dwordx4 v5, s[16:19], s90 offen nt lds
  s_and_b32 s91, s92, 0x1ffff
  s_mov_b32 m0, s91
  s_add_u32 s90, s91, s60
  s_add_u32 s92, s92, 1024
  buffer_load_dwordx4 v6, s[16:19], s90 offen nt lds
  s_and_b32 s91, s92, 0x1ffff
  s_mov_b32 m0, s91
  s_add_u32 s90, s91, s60
  s_add_u32 s92, s92, 1024
  buffer_load_dwordx4 v11, s[16:19], s90 offen nt lds
  s_and_b32 s91, s92, 0x1ffff
  s_mov_b32 m0, s91
  s_add_u32 s90, s91, s60
  s_add_u32 s92, s92, 1024
  buffer_load_dwordx4 v0, s[16:19], s90 offen nt lds
  s_and_b32 s91, s92, 0x1ffff
  s_mov_b32 m0, s91
  s_add_u32 s90, s91, s60
  s_add_u32 s92, s92, 1024
  buffer_load_dwordx4 v5, s[16:19], s90 offen nt lds
  s_and_b32 s91, s92, 0x1ffff
  s_mov_b32 m0, s91
  s_add_u32 s90, s91, s60
  s_add_u32 s92, s92, 1024
  buffer_load_dwordx4 v6, s[16:19], s90 offen nt lds
  s_and_b32 s91, s92, 0x1ffff
  s_mov_b32 m0, s91
  s_add_u32 s90, s91, s60
  s_add_u32 s92, s92, 1024
  buffer_load_dwordx4 v11, s[16:19], s90 offen nt lds
  s_and_b32 s91, s92, 0x1ffff
  s_mov_b32 m0, s91
  s_add_u32 s90, s91, s60
  s_add_u32 s92, s92, 1024
  buffer_load_dwordx4 v0, s[16:19], s90 offen nt lds
  s_and_b32 s91, s92, 0x1ffff
  s_mov_b32 m0, s91
  s_add_u32 s90, s91, s60
  s_add_u32 s92, s92, 1024
  buffer_load_dwordx4 v5, s[16:19], s90 offen nt lds
  s_and_b32 s91, s92, 0x1ffff
  s_mov_b32 m0, s91
  s_add_u32 s90, s91, s60
  s_add_u32 s92, s92, 1024
  buffer_load_dwordx4 v6, s[16:19], s90 offen nt lds
  s_and_b32 s91, s92, 0x1ffff
  s_mov_b32 m0, s91
  s_add_u32 s90, s91, s60
  s_add_u32 s92, s92, 1024
  buffer_load_dwordx4 v11, s[16:19], s90 offen nt lds
  s_and_b32 s91, s92, 0x1ffff
  s_mov_b32 m0, s91
  s_add_u32 s90, s91, s60
  s_add_u32 s92, s92, 1024
  buffer_load_dwordx4 v0, s[16:19], s90 offen nt lds
  s_and_b32 s91, s92, 0x1ffff
  s_mov_b32 m0, s91
  s_add_u32 s90, s91, s60
  s_add_u32 s92, s92, 1024
  buffer_load_dwordx4 v5, s[16:19], s90 offen nt lds
  s_and_b32 s91, s92, 0x1ffff
  s_mov_b32 m0, s91
  s_add_u32 s90, s91, s60
  s_add_u32 s92, s92, 1024
  buffer_load_dwordx4 v6, s[16:19], s90 offen nt lds
  s_and_b32 s91, s92, 0x1ffff
  s_mov_b32 m0, s91
  s_add_u32 s90, s91, s60
  s_add_u32 s92, s92, 1024
  buffer_load_dwordx4 v11, s[16:19], s90 offen nt lds
  s_and_b32 s91, s92, 0x1ffff
  s_mov_b32 m0, s91
  s_add_u32 s90, s91, s60
  s_add_u32 s92, s92, 1024
  buffer_load_dwordx4 v0, s[16:19], s90 offen nt lds
  s_and_b32 s91, s92, 0x1ffff
  s_mov_b32 m0, s91
  s_add_u32 s90, s91, s60
  s_add_u32 s92, s92, 1024
  buffer_load_dwordx4 v5, s[16:19], s90 offen nt lds
  s_and_b32 s91, s92, 0x1ffff
  s_mov_b32 m0, s91
  s_add_u32 s90, s91, s60
  s_add_u32 s92, s92, 1024
  buffer_load_dwordx4 v6, s[16:19], s90 offen nt lds
  s_and_b32 s91, s92, 0x1ffff
  s_mov_b32 m0, s91
  s_add_u32 s90, s91, s60
  s_add_u32 s92, s92, 1024
  buffer_load_dwordx4 v11, s[16:19], s90 offen nt lds
  s_and_b32 s91, s92, 0x1ffff
  s_mov_b32 m0, s91
  s_add_u32 s90, s91, s60
  s_add_u32 s92, s92, 1024
  buffer_load_dwordx4 v0, s[16:19], s90 offen nt lds
  s_and_b32 s91, s92, 0x1ffff
  s_mov_b32 m0, s91
  s_add_u32 s90, s91, s60
  s_add_u32 s92, s92, 1024
  buffer_load_dwordx4 v5, s[16:19], s90 offen nt lds
  s_and_b32 s91, s92, 0x1ffff
  s_mov_b32 m0, s91
  s_add_u32 s90, s91, s60
  s_add_u32 s92, s92, 1024
  buffer_load_dwordx4 v6, s[16:19], s90 offen nt lds
  s_and_b32 s91, s92, 0x1ffff
  s_mov_b32 m0, s91
  s_add_u32 s90, s91, s60
  s_add_u32 s92, s92, 1024
  buffer_load_dwordx4 v11, s[16:19], s90 offen nt lds
  s_and_b32 s91, s92, 0x1ffff
  s_mov_b32 m0, s91
  s_add_u32 s90, s91, s60
  s_add_u32 s92, s92, 1024
  buffer_load_dwordx4 v0, s[16:19], s90 offen nt lds
  s_and_b32 s91, s92, 0x1ffff
  s_mov_b32 m0, s91
  s_add_u32 s90, s91, s60
  s_add_u32 s92, s92, 1024
  buffer_load_dwordx4 v5, s[16:19], s90 offen nt lds
  s_and_b32 s91, s92, 0x1ffff
  s_mov_b32 m0, s91
  s_add_u32 s90, s91, s60
  s_add_u32 s92, s92, 1024
  buffer_load_dwordx4 v6, s[16:19], s90 offen nt lds
  s_and_b32 s91, s92, 0x1ffff
  s_mov_b32 m0, s91
  s_add_u32 s90, s91, s60
  s_add_u32 s92, s92, 1024
  buffer_load_dwordx4 v11, s[16:19], s90 offen nt lds
  s_and_b32 s91, s92, 0x1ffff
  s_mov_b32 m0, s91
  s_add_u32 s90, s91, s60
  s_add_u32 s92, s92, 1024
  buffer_load_dwordx4 v0, s[16:19], s90 offen nt lds
  s_and_b32 s91, s92, 0x1ffff
  s_mov_b32 m0, s91
  s_add_u32 s90, s91, s60
  s_add_u32 s92, s92, 1024
  buffer_load_dwordx4 v5, s[16:19], s90 offen nt lds
  s_and_b32 s91, s92, 0x1ffff
  s_mov_b32 m0, s91
  s_add_u32 s90, s91, s60
  s_add_u32 s92, s92, 1024
  buffer_load_dwordx4 v6, s[16:19], s90 offen nt lds
  s_and_b32 s91, s92, 0x1ffff
  s_mov_b32 m0, s91
  s_add_u32 s90, s91, s60
  s_add_u32 s92, s92, 1024
  buffer_load_dwordx4 v11, s[16:19], s90 offen nt lds
  s_and_b32 s91, s92, 0x1ffff
  s_mov_b32 m0, s91
  s_add_u32 s90, s91, s60
  s_add_u32 s92, s92, 1024
  buffer_load_dwordx4 v0, s[16:19], s90 offen nt lds
  s_and_b32 s91, s92, 0x1ffff
  s_mov_b32 m0, s91
  s_add_u32 s90, s91, s60
  s_add_u32 s92, s92, 1024
  buffer_load_dwordx4 v5, s[16:19], s90 offen nt lds
  s_and_b32 s91, s92, 0x1ffff
  s_mov_b32 m0, s91
  s_add_u32 s90, s91, s60
  s_add_u32 s92, s92, 1024
  buffer_load_dwordx4 v6, s[16:19], s90 offen nt lds
  s_and_b32 s91, s92, 0x1ffff
  s_mov_b32 m0, s91
  s_add_u32 s90, s91, s60
  s_add_u32 s92, s92, 1024
  buffer_load_dwordx4 v11, s[16:19], s90 offen nt lds
  s_and_b32 s91, s92, 0x1ffff
  s_mov_b32 m0, s91
  s_add_u32 s90, s91, s60
  s_add_u32 s92, s92, 1024
  buffer_load_dwordx4 v0, s[16:19], s90 offen nt lds
  s_and_b32 s91, s92, 0x1ffff
  s_mov_b32 m0, s91
  s_add_u32 s90, s91, s60
  s_add_u32 s92, s92, 1024
  buffer_load_dwordx4 v5, s[16:19], s90 offen nt lds
  s_and_b32 s91, s92, 0x1ffff
  s_mov_b32 m0, s91
  s_add_u32 s90, s91, s60
  s_add_u32 s92, s92, 1024
  buffer_load_dwordx4 v6, s[16:19], s90 offen nt lds
  s_and_b32 s91, s92, 0x1ffff
  s_mov_b32 m0, s91
  s_add_u32 s90, s91, s60
  s_add_u32 s92, s92, 1024
  buffer_load_dwordx4 v11, s[16:19], s90 offen nt lds
  s_and_b32 s91, s92, 0x1ffff
  s_mov_b32 m0, s91
  s_add_u32 s90, s91, s60
  s_add_u32 s92, s92, 1024
  buffer_load_dwordx4 v0, s[16:19], s90 offen nt lds
  s_and_b32 s91, s92, 0x1ffff
  s_mov_b32 m0, s91
  s_add_u32 s90, s91, s60
  s_add_u32 s92, s92, 1024
  buffer_load_dwordx4 v5, s[16:19], s90 offen nt lds
  s_and_b32 s91, s92, 0x1ffff
  s_mov_b32 m0, s91
  s_add_u32 s90, s91, s60
  s_add_u32 s92, s92, 1024
  buffer_load_dwordx4 v6, s[16:19], s90 offen nt lds
  s_and_b32 s91, s92, 0x1ffff
  s_mov_b32 m0, s91
  s_add_u32 s90, s91, s60
  s_add_u32 s92, s92, 1024
  buffer_load_dwordx4 v11, s[16:19], s90 offen nt lds
  s_and_b32 s91, s92, 0x1ffff
  s_mov_b32 m0, s91
  s_add_u32 s90, s91, s60
  s_add_u32 s92, s92, 1024
  buffer_load_dwordx4 v0, s[16:19], s90 offen nt lds
  s_and_b32 s91, s92, 0x1ffff
  s_mov_b32 m0, s91
  s_add_u32 s90, s91, s60
  s_add_u32 s92, s92, 1024
  buffer_load_dwordx4 v5, s[16:19], s90 offen nt lds
  s_and_b32 s91, s92, 0x1ffff
  s_mov_b32 m0, s91
  s_add_u32 s90, s91, s60
  s_add_u32 s92, s92, 1024
  buffer_load_dwordx4 v6, s[16:19], s90 offen nt lds
  s_and_b32 s91, s92, 0x1ffff
  s_mov_b32 m0, s91
  s_add_u32 s90, s91, s60
  s_add_u32 s92, s92, 1024
  buffer_load_dwordx4 v11, s[16:19], s90 offen nt lds
  s_and_b32 s91, s92, 0x1ffff
  s_mov_b32 m0, s91
  s_add_u32 s90, s91, s60
  s_add_u32 s92, s92, 1024
  buffer_load_dwordx4 v0, s[16:19], s90 offen nt lds
  s_and_b32 s91, s92, 0x1ffff
  s_mov_b32 m0, s91
  s_add_u32 s90, s91, s60
  s_add_u32 s92, s92, 1024
  buffer_load_dwordx4 v5, s[16:19], s90 offen nt lds
  s_and_b32 s91, s92, 0x1ffff
  s_mov_b32 m0, s91
  s_add_u32 s90, s91, s60
  s_add_u32 s92, s92, 1024
  buffer_load_dwordx4 v6, s[16:19], s90 offen nt lds
  s_and_b32 s91, s92, 0x1ffff
  s_mov_b32 m0, s91
  s_add_u32 s90, s91, s60
  s_add_u32 s92, s92, 1024
  buffer_load_dwordx4 v11, s[16:19], s90 offen nt lds
  s_and_b32 s91, s92, 0x1ffff
  s_mov_b32 m0, s91
  s_add_u32 s90, s91, s60
  s_add_u32 s92, s92, 1024
  buffer_load_dwordx4 v0, s[16:19], s90 offen nt lds
  s_and_b32 s91, s92, 0x1ffff
  s_mov_b32 m0, s91
  s_add_u32 s90, s91, s60
  s_add_u32 s92, s92, 1024
  buffer_load_dwordx4 v5, s[16:19], s90 offen nt lds
  s_and_b32 s91, s92, 0x1ffff
  s_mov_b32 m0, s91
  s_add_u32 s90, s91, s60
  s_add_u32 s92, s92, 1024
  buffer_load_dwordx4 v6, s[16:19], s90 offen nt lds
  s_and_b32 s91, s92, 0x1ffff
  s_mov_b32 m0, s91
  s_add_u32 s90, s91, s60
  s_add_u32 s92, s92, 1024
  buffer_load_dwordx4 v11, s[16:19], s90 offen nt lds
  s_and_b32 s91, s92, 0x1ffff
  s_mov_b32 m0, s91
  s_add_u32 s90, s91, s60
  s_add_u32 s92, s92, 1024
  buffer_load_dwordx4 v0, s[16:19], s90 offen nt lds
  s_and_b32 s91, s92, 0x1ffff
  s_mov_b32 m0, s91
  s_add_u32 s90, s91, s60
  s_add_u32 s92, s92, 1024
  buffer_load_dwordx4 v5, s[16:19], s90 offen nt lds
  s_and_b32 s91, s92, 0x1ffff
  s_mov_b32 m0, s91
  s_add_u32 s90, s91, s60
  s_add_u32 s92, s92, 1024
  buffer_load_dwordx4 v6, s[16:19], s90 offen nt lds
  s_and_b32 s91, s92, 0x1ffff
  s_mov_b32 m0, s91
  s_add_u32 s90, s91, s60
  s_add_u32 s92, s92, 1024
  buffer_load_dwordx4 v11, s[16:19], s90 offen nt lds
  s_and_b32 s91, s92, 0x1ffff
  s_mov_b32 m0, s91
  s_add_u32 s90, s91, s60
  s_add_u32 s92, s92, 1024
  buffer_load_dwordx4 v0, s[16:19], s90 offen nt lds
  s_and_b32 s91, s92, 0x1ffff
  s_mov_b32 m0, s91
  s_add_u32 s90, s91, s60
  s_add_u32 s92, s92, 1024
  buffer_load_dwordx4 v5, s[16:19], s90 offen nt lds
  s_and_b32 s91, s92, 0x1ffff
  s_mov_b32 m0, s91
  s_add_u32 s90, s91, s60
  s_add_u32 s92, s92, 1024
  buffer_load_dwordx4 v6, s[16:19], s90 offen nt lds
  s_and_b32 s91, s92, 0x1ffff
  s_mov_b32 m0, s91
  s_add_u32 s90, s91, s60
  s_add_u32 s92, s92, 1024
  buffer_load_dwordx4 v11, s[16:19], s90 offen nt lds
  s_and_b32 s91, s92, 0x1ffff
  s_mov_b32 m0, s91
  s_add_u32 s90, s91, s60
  s_add_u32 s92, s92, 1024
  buffer_load_dwordx4 v0, s[16:19], s90 offen nt lds
  s_and_b32 s91, s92, 0x1ffff
  s_mov_b32 m0, s91
  s_add_u32 s90, s91, s60
  s_add_u32 s92, s92, 1024
  buffer_load_dwordx4 v5, s[16:19], s90 offen nt lds
  s_and_b32 s91, s92, 0x1ffff
  s_mov_b32 m0, s91
  s_add_u32 s90, s91, s60
  s_add_u32 s92, s92, 1024
  buffer_load_dwordx4 v6, s[16:19], s90 offen nt lds
  s_and_b32 s91, s92, 0x1ffff
  s_mov_b32 m0, s91
  s_add_u32 s90, s91, s60
  s_add_u32 s92, s92, 1024
  buffer_load_dwordx4 v11, s[16:19], s90 offen nt lds
  s_and_b32 s91, s92, 0x1ffff
  s_mov_b32 m0, s91
  s_add_u32 s90, s91, s60
  s_add_u32 s92, s92, 1024
  buffer_load_dwordx4 v0, s[16:19], s90 offen nt lds
  s_and_b32 s91, s92, 0x1ffff
  s_mov_b32 m0, s91
  s_add_u32 s90, s91, s60
  s_add_u32 s92, s92, 1024
  buffer_load_dwordx4 v5, s[16:19], s90 offen nt lds
  s_and_b32 s91, s92, 0x1ffff
  s_mov_b32 m0, s91
  s_add_u32 s90, s91, s60
  s_add_u32 s92, s92, 1024
  buffer_load_dwordx4 v6, s[16:19], s90 offen nt lds
  s_and_b32 s91, s92, 0x1ffff
  s_mov_b32 m0, s91
  s_add_u32 s90, s91, s60
  s_add_u32 s92, s92, 1024
  buffer_load_dwordx4 v11, s[16:19], s90 offen nt lds
  s_and_b32 s91, s92, 0x1ffff
  s_mov_b32 m0, s91
  s_add_u32 s90, s91, s60
  s_add_u32 s92, s92, 1024
  buffer_load_dwordx4 v0, s[16:19], s90 offen nt lds
  s_waitcnt vmcnt(32)
  s_barrier
  s_and_b32 s91, s92, 0x1ffff
  s_mov_b32 m0, s91
  s_add_u32 s90, s91, s60
  s_add_u32 s92, s92, 1024
  buffer_load_dwordx4 v5, s[16:19], s90 offen nt lds
  s_and_b32 s91, s92, 0x1ffff
  s_mov_b32 m0, s91
  s_add_u32 s90, s91, s60
  s_add_u32 s92, s92, 1024
  buffer_load_dwordx4 v6, s[16:19], s90 offen nt lds
  s_and_b32 s91, s92, 0x1ffff
  s_mov_b32 m0, s91
  s_add_u32 s90, s91, s60
  s_add_u32 s92, s92, 1024
  buffer_load_dwordx4 v11, s[16:19], s90 offen nt lds
  s_and_b32 s91, s92, 0x1ffff
  s_mov_b32 m0, s91
  s_add_u32 s90, s91, s60
  s_add_u32 s92, s92, 1024
  buffer_load_dwordx4 v0, s[16:19], s90 offen nt lds
  s_and_b32 s91, s92, 0x1ffff
  s_mov_b32 m0, s91
  s_add_u32 s90, s91, s60
  s_add_u32 s92, s92, 1024
  buffer_load_dwordx4 v5, s[16:19], s90 offen nt lds
  s_and_b32 s91, s92, 0x1ffff
  s_mov_b32 m0, s91
  s_add_u32 s90, s91, s60
  s_add_u32 s92, s92, 1024
  buffer_load_dwordx4 v6, s[16:19], s90 offen nt lds
  s_and_b32 s91, s92, 0x1ffff
  s_mov_b32 m0, s91
  s_add_u32 s90, s91, s60
  s_add_u32 s92, s92, 1024
  buffer_load_dwordx4 v11, s[16:19], s90 offen nt lds
  s_and_b32 s91, s92, 0x1ffff
  s_mov_b32 m0, s91
  s_add_u32 s90, s91, s60
  s_add_u32 s92, s92, 1024
  buffer_load_dwordx4 v0, s[16:19], s90 offen nt lds
  s_and_b32 s91, s92, 0x1ffff
  s_mov_b32 m0, s91
  s_add_u32 s90, s91, s60
  s_add_u32 s92, s92, 1024
  buffer_load_dwordx4 v5, s[16:19], s90 offen nt lds
  s_and_b32 s91, s92, 0x1ffff
  s_mov_b32 m0, s91
  s_add_u32 s90, s91, s60
  s_add_u32 s92, s92, 1024
  buffer_load_dwordx4 v6, s[16:19], s90 offen nt lds
  s_and_b32 s91, s92, 0x1ffff
  s_mov_b32 m0, s91
  s_add_u32 s90, s91, s60
  s_add_u32 s92, s92, 1024
  buffer_load_dwordx4 v11, s[16:19], s90 offen nt lds
  s_and_b32 s91, s92, 0x1ffff
  s_mov_b32 m0, s91
  s_add_u32 s90, s91, s60
  s_add_u32 s92, s92, 1024
  buffer_load_dwordx4 v0, s[16:19], s90 offen nt lds
  s_and_b32 s91, s92, 0x1ffff
  s_mov_b32 m0, s91
  s_add_u32 s90, s91, s60
  s_add_u32 s92, s92, 1024
  buffer_load_dwordx4 v5, s[16:19], s90 offen nt lds
  s_and_b32 s91, s92, 0x1ffff
  s_mov_b32 m0, s91
  s_add_u32 s90, s91, s60
  s_add_u32 s92, s92, 1024
  buffer_load_dwordx4 v6, s[16:19], s90 offen nt lds
  s_and_b32 s91, s92, 0x1ffff
  s_mov_b32 m0, s91
  s_add_u32 s90, s91, s60
  s_add_u32 s92, s92, 1024
  buffer_load_dwordx4 v11, s[16:19], s90 offen nt lds
  s_and_b32 s91, s92, 0x1ffff
  s_mov_b32 m0, s91
  s_add_u32 s90, s91, s60
  s_add_u32 s92, s92, 1024
  buffer_load_dwordx4 v0, s[16:19], s90 offen nt lds
  s_and_b32 s91, s92, 0x1ffff
  s_mov_b32 m0, s91
  s_add_u32 s90, s91, s60
  s_add_u32 s92, s92, 1024
  buffer_load_dwordx4 v5, s[16:19], s90 offen nt lds
  s_and_b32 s91, s92, 0x1ffff
  s_mov_b32 m0, s91
  s_add_u32 s90, s91, s60
  s_add_u32 s92, s92, 1024
  buffer_load_dwordx4 v6, s[16:19], s90 offen nt lds
  s_and_b32 s91, s92, 0x1ffff
  s_mov_b32 m0, s91
  s_add_u32 s90, s91, s60
  s_add_u32 s92, s92, 1024
  buffer_load_dwordx4 v11, s[16:19], s90 offen nt lds
  s_and_b32 s91, s92, 0x1ffff
  s_mov_b32 m0, s91
  s_add_u32 s90, s91, s60
  s_add_u32 s92, s92, 1024
  buffer_load_dwordx4 v0, s[16:19], s90 offen nt lds
  s_and_b32 s91, s92, 0x1ffff
  s_mov_b32 m0, s91
  s_add_u32 s90, s91, s60
  s_add_u32 s92, s92, 1024
  buffer_load_dwordx4 v5, s[16:19], s90 offen nt lds
  s_and_b32 s91, s92, 0x1ffff
  s_mov_b32 m0, s91
  s_add_u32 s90, s91, s60
  s_add_u32 s92, s92, 1024
  buffer_load_dwordx4 v6, s[16:19], s90 offen nt lds
  s_and_b32 s91, s92, 0x1ffff
  s_mov_b32 m0, s91
  s_add_u32 s90, s91, s60
  s_add_u32 s92, s92, 1024
  buffer_load_dwordx4 v11, s[16:19], s90 offen nt lds
  s_and_b32 s91, s92, 0x1ffff
  s_mov_b32 m0, s91
  s_add_u32 s90, s91, s60
  s_add_u32 s92, s92, 1024
  buffer_load_dwordx4 v0, s[16:19], s90 offen nt lds
  s_waitcnt vmcnt(24)
  s_barrier
  s_lshl_b32 s90, s53, 9
  s_lshl_b32 s3, s57, 4
  s_add_u32 s90, s90, s3
  s_lshl_b32 s90, s90, 10
  s_lshl_b32 s3, s58, 8
  s_add_u32 s90, s90, s3
  s_mov_b32 m0, 0x20000
  s_add_u32 s91, s90, 0
  buffer_load_dwordx4 v7, s[24:27], s91 offen nt lds
  s_mov_b32 m0, 0x20400
  s_add_u32 s91, s90, 4096
  buffer_load_dwordx4 v8, s[24:27], s91 offen nt lds
  s_mov_b32 m0, 0x20800
  s_add_u32 s91, s90, 8192
  buffer_load_dwordx4 v7, s[24:27], s91 offen nt lds
  s_mov_b32 m0, 0x20c00
  s_add_u32 s91, s90, 12288
  buffer_load_dwordx4 v8, s[24:27], s91 offen nt lds
  s_mov_b32 m0, 0x21000
  s_add_u32 s91, s90, 131072
  buffer_load_dwordx4 v7, s[24:27], s91 offen nt lds
  s_mov_b32 m0, 0x21400
  s_add_u32 s91, s90, 135168
  buffer_load_dwordx4 v8, s[24:27], s91 offen nt lds
  s_mov_b32 m0, 0x21800
  s_add_u32 s91, s90, 139264
  buffer_load_dwordx4 v7, s[24:27], s91 offen nt lds
  s_mov_b32 m0, 0x21c00
  s_add_u32 s91, s90, 143360
  buffer_load_dwordx4 v8, s[24:27], s91 offen nt lds
  s_mov_b32 m0, 0x22000
  s_add_u32 s91, s90, 262144
  buffer_load_dwordx4 v7, s[24:27], s91 offen nt lds
  s_mov_b32 m0, 0x22400
  s_add_u32 s91, s90, 266240
  buffer_load_dwordx4 v8, s[24:27], s91 offen nt lds
  s_mov_b32 m0, 0x22800
  s_add_u32 s91, s90, 270336
  buffer_load_dwordx4 v7, s[24:27], s91 offen nt lds
  s_mov_b32 m0, 0x22c00
  s_add_u32 s91, s90, 274432
  buffer_load_dwordx4 v8, s[24:27], s91 offen nt lds
  s_mov_b32 m0, 0x23000
  s_add_u32 s91, s90, 393216
  buffer_load_dwordx4 v7, s[24:27], s91 offen nt lds
  s_mov_b32 m0, 0x23400
  s_add_u32 s91, s90, 397312
  buffer_load_dwordx4 v8, s[24:27], s91 offen nt lds
  s_mov_b32 m0, 0x23800
  s_add_u32 s91, s90, 401408
  buffer_load_dwordx4 v7, s[24:27], s91 offen nt lds
  s_mov_b32 m0, 0x23c00
  s_add_u32 s91, s90, 405504
  buffer_load_dwordx4 v8, s[24:27], s91 offen nt lds
  v_and_b32 v13, 3, v3
  v_lshl_add_u32 v13, v2, 2, v13
  v_lshlrev_b32 v13, 4, v13
  v_add_u32 v13, 0x24000, v13
  s_add_u32 s3, s89, 0
  s_and_b32 s3, s3, 15
  s_lshl_b32 s3, s3, 8
  v_add_u32 v14, s3, v13
  ds_read_b128 v[128:131], v14
  s_add_u32 s3, s89, 1
  s_and_b32 s3, s3, 15
  s_lshl_b32 s3, s3, 8
  v_add_u32 v14, s3, v13
  ds_read_b128 v[132:135], v14
  s_add_u32 s3, s89, 2
  s_and_b32 s3, s3, 15
  s_lshl_b32 s3, s3, 8
  v_add_u32 v14, s3, v13
  ds_read_b128 v[136:139], v14
  s_add_u32 s3, s89, 3
  s_and_b32 s3, s3, 15
  s_lshl_b32 s3, s3, 8
  v_add_u32 v14, s3, v13
  ds_read_b128 v[140:143], v14
  s_add_u32 s3, s89, 4
  s_and_b32 s3, s3, 15
  s_lshl_b32 s3, s3, 8
  v_add_u32 v14, s3, v13
  ds_read_b128 v[144:147], v14
  s_add_u32 s3, s89, 5
  s_and_b32 s3, s3, 15
  s_lshl_b32 s3, s3, 8
  v_add_u32 v14, s3, v13
  ds_read_b128 v[148:151], v14
  s_add_u32 s3, s89, 6
  s_and_b32 s3, s3, 15
  s_lshl_b32 s3, s3, 8
  v_add_u32 v14, s3, v13
  ds_read_b128 v[152:155], v14
  s_add_u32 s3, s89, 7
  s_and_b32 s3, s3, 15
  s_lshl_b32 s3, s3, 8
  v_add_u32 v14, s3, v13
  ds_read_b128 v[156:159], v14
  v_add_u32 v14, 0x25000, v9
  ds_read_b64_tr_b16 v[32:33], v14
  ds_read_b64_tr_b16 v[34:35], v14 offset:4096
  v_xor_b32 v14, 32, v14
  ds_read_b64_tr_b16 v[28:29], v14
  ds_read_b64_tr_b16 v[30:31], v14 offset:4096
  v_lshrrev_b32 v14, 3, v3
  v_and_b32 v15, 1, v3
  v_lshl_add_u32 v14, v15, 1, v14
  v_lshlrev_b32 v14, 6, v14
  v_lshl_add_u32 v14, v2, 4, v14
  v_add_u32 v14, 0x27400, v14
  ds_read_b128 v[48:51], v14
  v_lshrrev_b32 v14, 1, v2
  v_lshlrev_b32 v14, 2, v14
  v_add_u32 v14, 0x27590, v14
  ds_read_b32 v52, v14
  ds_read_b32 v53, v14 offset:8
  v_mov_b32 v14, 0x27630
  ds_read_b32 v62, v14
  s_waitcnt lgkmcnt(0)
  s_add_u32 s3, s89, 8
  s_and_b32 s3, s3, 15
  s_lshl_b32 s3, s3, 8
  v_add_u32 v14, s3, v13
  ds_read_b128 v[160:163], v14
  s_add_u32 s3, s89, 9
  s_and_b32 s3, s3, 15
  s_lshl_b32 s3, s3, 8
  v_add_u32 v14, s3, v13
  ds_read_b128 v[164:167], v14
  s_add_u32 s3, s89, 10
  s_and_b32 s3, s3, 15
  s_lshl_b32 s3, s3, 8
  v_add_u32 v14, s3, v13
  ds_read_b128 v[168:171], v14
  s_add_u32 s3, s89, 11
  s_and_b32 s3, s3, 15
  s_lshl_b32 s3, s3, 8
  v_add_u32 v14, s3, v13
  ds_read_b128 v[172:175], v14
  s_add_u32 s3, s89, 12
  s_and_b32 s3, s3, 15
  s_lshl_b32 s3, s3, 8
  v_add_u32 v14, s3, v13
  ds_read_b128 v[176:179], v14
  s_add_u32 s3, s89, 13
  s_and_b32 s3, s3, 15
  s_lshl_b32 s3, s3, 8
  v_add_u32 v14, s3, v13
  ds_read_b128 v[180:183], v14
  s_add_u32 s3, s89, 14
  s_and_b32 s3, s3, 15
  s_lshl_b32 s3, s3, 8
  v_add_u32 v14, s3, v13
  ds_read_b128 v[184:187], v14
  s_add_u32 s3, s89, 15
  s_and_b32 s3, s3, 15
  s_lshl_b32 s3, s3, 8
  v_add_u32 v14, s3, v13
  ds_read_b128 v[188:191], v14
  v_mfma_f32_16x16x32_bf16 v[36:39], v[48:51], v[32:35], 0
  v_mfma_f32_16x16x32_bf16 v[228:231], v[48:51], v[28:31], 0
  v_readfirstlane_b32 s101, v62
  v_mov_b32 v25, s59
  v_mov_b32 v27, s59
  v_and_b32 v13, 1, v2
  v_cmp_eq_u32 vcc, 1, v13
  s_nop 2
  v_mul_f32 v36, v36, v52
  v_mul_f32 v38, v37, v53
  v_mov_b32 v37, s59
  v_mov_b32 v39, s59
  v_xor_b32 v62, 32, v57
  v_mul_f32 v228, v228, v52
  v_mul_f32 v230, v229, v53
  v_mov_b32 v229, s59
  v_mov_b32 v231, s59
  s_waitcnt lgkmcnt(0)
  s_add_u32 s3, s89, 0
  s_and_b32 s3, s3, 15
  s_lshl_b32 s3, s3, 13
  v_add_u32 v224, s3, v12
  s_add_u32 s3, s89, 1
  s_and_b32 s3, s3, 15
  s_lshl_b32 s3, s3, 13
  v_add_u32 v225, s3, v12
  s_add_u32 s3, s89, 2
  s_and_b32 s3, s3, 15
  s_lshl_b32 s3, s3, 13
  v_add_u32 v226, s3, v12
  s_add_u32 s3, s89, 3
  s_and_b32 s3, s3, 15
  s_lshl_b32 s3, s3, 13
  v_add_u32 v227, s3, v12
  ds_read_b64_tr_b16 v[192:193], v224
  ds_read_b64_tr_b16 v[194:195], v224 offset:4096
  ds_read_b64_tr_b16 v[196:197], v225
  ds_read_b64_tr_b16 v[198:199], v225 offset:4096
  ds_read_b64_tr_b16 v[200:201], v226
  ds_read_b64_tr_b16 v[202:203], v226 offset:4096
  ds_read_b64_tr_b16 v[204:205], v227
  ds_read_b64_tr_b16 v[206:207], v227 offset:4096
  s_waitcnt lgkmcnt(6)
  v_mfma_f32_16x16x32_bf16 v[16:19], v[192:195], v[128:131], 0
  s_waitcnt lgkmcnt(4)
  v_mfma_f32_16x16x32_bf16 v[16:19], v[196:199], v[132:135], v[16:19]
  s_waitcnt lgkmcnt(2)
  v_mfma_f32_16x16x32_bf16 v[16:19], v[200:203], v[136:139], v[16:19]
  s_waitcnt lgkmcnt(0)
  v_mfma_f32_16x16x32_bf16 v[16:19], v[204:207], v[140:143], v[16:19]
  s_add_u32 s3, s89, 4
  s_and_b32 s3, s3, 15
  s_lshl_b32 s3, s3, 13
  v_add_u32 v224, s3, v12
  s_add_u32 s3, s89, 5
  s_and_b32 s3, s3, 15
  s_lshl_b32 s3, s3, 13
  v_add_u32 v225, s3, v12
  s_add_u32 s3, s89, 6
  s_and_b32 s3, s3, 15
  s_lshl_b32 s3, s3, 13
  v_add_u32 v226, s3, v12
  s_add_u32 s3, s89, 7
  s_and_b32 s3, s3, 15
  s_lshl_b32 s3, s3, 13
  v_add_u32 v227, s3, v12
  ds_read_b64_tr_b16 v[208:209], v224
  ds_read_b64_tr_b16 v[210:211], v224 offset:4096
  ds_read_b64_tr_b16 v[212:213], v225
  ds_read_b64_tr_b16 v[214:215], v225 offset:4096
  ds_read_b64_tr_b16 v[216:217], v226
  ds_read_b64_tr_b16 v[218:219], v226 offset:4096
  ds_read_b64_tr_b16 v[220:221], v227
  ds_read_b64_tr_b16 v[222:223], v227 offset:4096
  s_waitcnt lgkmcnt(6)
  v_mfma_f32_16x16x32_bf16 v[16:19], v[208:211], v[144:147], v[16:19]
  s_waitcnt lgkmcnt(4)
  v_mfma_f32_16x16x32_bf16 v[16:19], v[212:215], v[148:151], v[16:19]
  s_waitcnt lgkmcnt(2)
  v_mfma_f32_16x16x32_bf16 v[16:19], v[216:219], v[152:155], v[16:19]
  s_waitcnt lgkmcnt(0)
  v_mfma_f32_16x16x32_bf16 v[16:19], v[220:223], v[156:159], v[16:19]
  s_add_u32 s3, s89, 8
  s_and_b32 s3, s3, 15
  s_lshl_b32 s3, s3, 13
  v_add_u32 v224, s3, v12
  s_add_u32 s3, s89, 9
  s_and_b32 s3, s3, 15
  s_lshl_b32 s3, s3, 13
  v_add_u32 v225, s3, v12
  s_add_u32 s3, s89, 10
  s_and_b32 s3, s3, 15
  s_lshl_b32 s3, s3, 13
  v_add_u32 v226, s3, v12
  s_add_u32 s3, s89, 11
  s_and_b32 s3, s3, 15
  s_lshl_b32 s3, s3, 13
  v_add_u32 v227, s3, v12
  ds_read_b64_tr_b16 v[192:193], v224
  ds_read_b64_tr_b16 v[194:195], v224 offset:4096
  ds_read_b64_tr_b16 v[196:197], v225
  ds_read_b64_tr_b16 v[198:199], v225 offset:4096
  ds_read_b64_tr_b16 v[200:201], v226
  ds_read_b64_tr_b16 v[202:203], v226 offset:4096
  ds_read_b64_tr_b16 v[204:205], v227
  ds_read_b64_tr_b16 v[206:207], v227 offset:4096
  s_waitcnt lgkmcnt(6)
  v_mfma_f32_16x16x32_bf16 v[16:19], v[192:195], v[160:163], v[16:19]
  s_waitcnt lgkmcnt(4)
  v_mfma_f32_16x16x32_bf16 v[16:19], v[196:199], v[164:167], v[16:19]
  s_waitcnt lgkmcnt(2)
  v_mfma_f32_16x16x32_bf16 v[16:19], v[200:203], v[168:171], v[16:19]
  s_waitcnt lgkmcnt(0)
  v_mfma_f32_16x16x32_bf16 v[16:19], v[204:207], v[172:175], v[16:19]
  s_add_u32 s3, s89, 12
  s_and_b32 s3, s3, 15
  s_lshl_b32 s3, s3, 13
  v_add_u32 v224, s3, v12
  s_add_u32 s3, s89, 13
  s_and_b32 s3, s3, 15
  s_lshl_b32 s3, s3, 13
  v_add_u32 v225, s3, v12
  s_add_u32 s3, s89, 14
  s_and_b32 s3, s3, 15
  s_lshl_b32 s3, s3, 13
  v_add_u32 v226, s3, v12
  s_add_u32 s3, s89, 15
  s_and_b32 s3, s3, 15
  s_lshl_b32 s3, s3, 13
  v_add_u32 v227, s3, v12
  s_waitcnt vmcnt(16)
  s_branch L_b3b
L_C:
  v_and_b32 v13, 3, v3
  v_lshlrev_b32 v21, 8, v13
  v_lshrrev_b32 v15, 2, v3
  v_lshl_add_u32 v21, v15, 6, v21
  v_lshl_add_u32 v21, v2, 4, v21
  v_add_u32 v21, 0x27000, v21
  v_lshlrev_b32 v22, 4, v13
  v_add_u32 v22, 0x27500, v22
  s_lshl_b32 s3, s52, 2
  v_add_u32 v23, s3, v22
  s_add_u32 s90, s88, s52
  s_lshr_b32 s91, s90, 2
  v_add_u32 v20, s91, v15
  v_and_b32 v14, 1, v20
  v_lshrrev_b32 v20, 1, v20
  v_lshlrev_b32 v19, 4, v13
  v_lshl_add_u32 v19, v2, 6, v19
  v_lshl_add_u32 v19, v14, 3, v19
  s_and_b32 s90, s90, 3
  s_lshl_b32 s90, s90, 1
  s_add_u32 s90, s90, 0x24000
  v_add_u32 v19, s90, v19
  v_lshlrev_b32 v58, 6, v3
  v_lshl_add_u32 v58, v2, 4, v58
  s_lshl_b32 s4, s96, 11
  s_lshl_b32 s3, s52, 8
  s_add_u32 s4, s4, s3
  s_add_u32 s4, s4, 0x40000
  s_lshr_b32 s5, s52, 1
  s_lshl_b32 s5, s5, 3
  s_add_u32 s5, s5, s53
  s_lshl_b32 s5, s5, 3
  s_and_b32 s3, s52, 1
  s_lshl_b32 s3, s3, 2
  s_add_u32 s5, s5, s3
  s_lshl_b32 s5, s5, 11
  s_lshl_b32 s3, s57, 8
  s_add_u32 s5, s5, s3
  s_add_u32 s5, s5, 0x40000
  v_lshlrev_b32 v59, 11, v2
  v_lshl_add_u32 v59, v3, 4, v59
  v_lshrrev_b32 v13, 3, v3
  v_lshlrev_b32 v13, 2, v13
  v_and_b32 v14, 3, v3
  v_add_u32 v13, v13, v14
  s_and_b32 s3, s52, 1
  s_lshl_b32 s3, s3, 2
  v_add_u32 v14, s3, v2
  v_xor_b32 v13, v13, v14
  v_lshlrev_b32 v13, 4, v13
  v_lshrrev_b32 v14, 2, v3
  v_and_b32 v14, 1, v14
  v_lshl_add_u32 v13, v14, 3, v13
  v_lshl_add_u32 v13, v2, 7, v13
  s_lshl_b32 s3, s52, 9
  s_add_u32 s3, s3, 0x26000
  v_add_u32 v60, s3, v13
  v_lshrrev_b32 v13, 2, v3
  v_lshlrev_b32 v13, 2, v13
  v_lshl_add_u32 v13, v2, 4, v13
  s_lshl_b32 s3, s52, 6
  s_add_u32 s3, s3, 0x27800
  v_add_u32 v61, s3, v13
  v_and_b32 v14, 7, v3
  v_xor_b32 v54, v2, v14
  v_xor_b32 v55, 4, v54
  v_lshlrev_b32 v54, 4, v54
  v_lshlrev_b32 v55, 4, v55
  v_lshl_add_u32 v54, v3, 7, v54
  v_lshl_add_u32 v55, v3, 7, v55
  v_add_u32 v54, 0x26000, v54
  v_add_u32 v55, 0x26000, v55
  v_add_u32 v57, 0x20000, v9
  v_lshrrev_b32 v63, 1, v2
  v_lshlrev_b32 v63, 19, v63
  v_lshrrev_b32 v13, 3, v3
  v_lshl_add_u32 v63, v13, 13, v63
  v_and_b32 v13, 7, v3
  v_lshl_add_u32 v63, v13, 4, v63
  s_lshl_b32 s7, s58, 3
  s_lshl_b32 s3, s52, 1
  s_and_b32 s3, s3, 7
  s_add_u32 s7, s7, s3
  s_lshl_b32 s7, s7, 14
  s_lshl_b32 s3, s97, 7
  s_add_u32 s7, s7, s3
  s_add_u32 s7, s7, 0x100000
  s_add_u32 s6, s7, 16384
  v_mov_b32 v13, 0x27610
L_spin2:
  ds_read_b128 v[24:27], v13
  s_waitcnt lgkmcnt(0)
  v_cmp_ne_u32 vcc, 1, v24
  v_cmp_ne_u32 s[62:63], 1, v25
  s_or_b64 vcc, vcc, s[62:63]
  v_cmp_ne_u32 s[62:63], 1, v26
  s_or_b64 vcc, vcc, s[62:63]
  s_cbranch_vccz L_spin2_ok
  s_sub_u32 s61, s61, 1
  s_cbranch_scc1 L_end
  s_sleep 2
  s_branch L_spin2
L_spin2_ok:
  ds_read_b128 v[28:31], v21
  s_waitcnt vmcnt(0) lgkmcnt(0)
  v_mfma_f32_16x16x32_bf16 v[192:195], v[64:67], v[28:31], 0
  v_mfma_f32_16x16x32_bf16 v[196:199], v[68:71], v[28:31], 0
  v_mfma_f32_16x16x32_bf16 v[200:203], v[72:75], v[28:31], 0
  v_mfma_f32_16x16x32_bf16 v[204:207], v[76:79], v[28:31], 0
  v_mfma_f32_16x16x32_bf16 v[208:211], v[80:83], v[28:31], 0
  v_mfma_f32_16x16x32_bf16 v[212:215], v[84:87], v[28:31], 0
  v_mfma_f32_16x16x32_bf16 v[216:219], v[88:91], v[28:31], 0
  v_mfma_f32_16x16x32_bf16 v[220:223], v[92:95], v[28:31], 0
  v_mfma_f32_16x16x32_bf16 v[224:227], v[96:99], v[28:31], 0
  v_mfma_f32_16x16x32_bf16 v[228:231], v[100:103], v[28:31], 0
  v_mfma_f32_16x16x32_bf16 v[232:235], v[104:107], v[28:31], 0
  v_mfma_f32_16x16x32_bf16 v[236:239], v[108:111], v[28:31], 0
  v_mfma_f32_16x16x32_bf16 v[240:243], v[112:115], v[28:31], 0
  v_mfma_f32_16x16x32_bf16 v[244:247], v[116:119], v[28:31], 0
  v_mfma_f32_16x16x32_bf16 v[248:251], v[120:123], v[28:31], 0
  v_mfma_f32_16x16x32_bf16 v[252:255], v[124:127], v[28:31], 0
  s_nop 2
  v_mov_b32_dpp v40, v192 quad_perm:[0,1,2,3] row_mask:0xf bank_mask:0x1
  v_mov_b32_dpp v41, v208 quad_perm:[0,1,2,3] row_mask:0xf bank_mask:0x1
  v_mov_b32_dpp v42, v224 quad_perm:[0,1,2,3] row_mask:0xf bank_mask:0x1
  v_mov_b32_dpp v43, v240 quad_perm:[0,1,2,3] row_mask:0xf bank_mask:0x1
  v_add_f32_dpp v40, v193, v40 row_ror:12 row_mask:0xf bank_mask:0x1
  v_add_f32_dpp v41, v209, v41 row_ror:12 row_mask:0xf bank_mask:0x1
  v_add_f32_dpp v42, v225, v42 row_ror:12 row_mask:0xf bank_mask:0x1
  v_add_f32_dpp v43, v241, v43 row_ror:12 row_mask:0xf bank_mask:0x1
  v_add_f32_dpp v40, v194, v40 row_ror:8 row_mask:0xf bank_mask:0x1
  v_add_f32_dpp v41, v210, v41 row_ror:8 row_mask:0xf bank_mask:0x1
  v_add_f32_dpp v42, v226, v42 row_ror:8 row_mask:0xf bank_mask:0x1
  v_add_f32_dpp v43, v242, v43 row_ror:8 row_mask:0xf bank_mask:0x1
  v_add_f32_dpp v40, v195, v40 row_ror:4 row_mask:0xf bank_mask:0x1
  v_add_f32_dpp v41, v211, v41 row_ror:4 row_mask:0xf bank_mask:0x1
  v_add_f32_dpp v42, v227, v42 row_ror:4 row_mask:0xf bank_mask:0x1
  v_add_f32_dpp v43, v243, v43 row_ror:4 row_mask:0xf bank_mask:0x1
  v_mov_b32_dpp v40, v196 row_ror:4 row_mask:0xf bank_mask:0x2
  v_mov_b32_dpp v41, v212 row_ror:4 row_mask:0xf bank_mask:0x2
  v_mov_b32_dpp v42, v228 row_ror:4 row_mask:0xf bank_mask:0x2
  v_mov_b32_dpp v43, v244 row_ror:4 row_mask:0xf bank_mask:0x2
  v_add_f32_dpp v40, v197, v40 quad_perm:[0,1,2,3] row_mask:0xf bank_mask:0x2
  v_add_f32_dpp v41, v213, v41 quad_perm:[0,1,2,3] row_mask:0xf bank_mask:0x2
  v_add_f32_dpp v42, v229, v42 quad_perm:[0,1,2,3] row_mask:0xf bank_mask:0x2
  v_add_f32_dpp v43, v245, v43 quad_perm:[0,1,2,3] row_mask:0xf bank_mask:0x2
  v_add_f32_dpp v40, v198, v40 row_ror:12 row_mask:0xf bank_mask:0x2
  v_add_f32_dpp v41, v214, v41 row_ror:12 row_mask:0xf bank_mask:0x2
  v_add_f32_dpp v42, v230, v42 row_ror:12 row_mask:0xf bank_mask:0x2
  v_add_f32_dpp v43, v246, v43 row_ror:12 row_mask:0xf bank_mask:0x2
  v_add_f32_dpp v40, v199, v40 row_ror:8 row_mask:0xf bank_mask:0x2
  v_add_f32_dpp v41, v215, v41 row_ror:8 row_mask:0xf bank_mask:0x2
  v_add_f32_dpp v42, v231, v42 row_ror:8 row_mask:0xf bank_mask:0x2
  v_add_f32_dpp v43, v247, v43 row_ror:8 row_mask:0xf bank_mask:0x2
  v_mov_b32_dpp v40, v200 row_ror:8 row_mask:0xf bank_mask:0x4
  v_mov_b32_dpp v41, v216 row_ror:8 row_mask:0xf bank_mask:0x4
  v_mov_b32_dpp v42, v232 row_ror:8 row_mask:0xf bank_mask:0x4
  v_mov_b32_dpp v43, v248 row_ror:8 row_mask:0xf bank_mask:0x4
  v_add_f32_dpp v40, v201, v40 row_ror:4 row_mask:0xf bank_mask:0x4
  v_add_f32_dpp v41, v217, v41 row_ror:4 row_mask:0xf bank_mask:0x4
  v_add_f32_dpp v42, v233, v42 row_ror:4 row_mask:0xf bank_mask:0x4
  v_add_f32_dpp v43, v249, v43 row_ror:4 row_mask:0xf bank_mask:0x4
  v_add_f32_dpp v40, v202, v40 quad_perm:[0,1,2,3] row_mask:0xf bank_mask:0x4
  v_add_f32_dpp v41, v218, v41 quad_perm:[0,1,2,3] row_mask:0xf bank_mask:0x4
  v_add_f32_dpp v42, v234, v42 quad_perm:[0,1,2,3] row_mask:0xf bank_mask:0x4
  v_add_f32_dpp v43, v250, v43 quad_perm:[0,1,2,3] row_mask:0xf bank_mask:0x4
  v_add_f32_dpp v40, v203, v40 row_ror:12 row_mask:0xf bank_mask:0x4
  v_add_f32_dpp v41, v219, v41 row_ror:12 row_mask:0xf bank_mask:0x4
  v_add_f32_dpp v42, v235, v42 row_ror:12 row_mask:0xf bank_mask:0x4
  v_add_f32_dpp v43, v251, v43 row_ror:12 row_mask:0xf bank_mask:0x4
  v_mov_b32_dpp v40, v204 row_ror:12 row_mask:0xf bank_mask:0x8
  v_mov_b32_dpp v41, v220 row_ror:12 row_mask:0xf bank_mask:0x8
  v_mov_b32_dpp v42, v236 row_ror:12 row_mask:0xf bank_mask:0x8
  v_mov_b32_dpp v43, v252 row_ror:12 row_mask:0xf bank_mask:0x8
  v_add_f32_dpp v40, v205, v40 row_ror:8 row_mask:0xf bank_mask:0x8
  v_add_f32_dpp v41, v221, v41 row_ror:8 row_mask:0xf bank_mask:0x8
  v_add_f32_dpp v42, v237, v42 row_ror:8 row_mask:0xf bank_mask:0x8
  v_add_f32_dpp v43, v253, v43 row_ror:8 row_mask:0xf bank_mask:0x8
  v_add_f32_dpp v40, v206, v40 row_ror:4 row_mask:0xf bank_mask:0x8
  v_add_f32_dpp v41, v222, v41 row_ror:4 row_mask:0xf bank_mask:0x8
  v_add_f32_dpp v42, v238, v42 row_ror:4 row_mask:0xf bank_mask:0x8
  v_add_f32_dpp v43, v254, v43 row_ror:4 row_mask:0xf bank_mask:0x8
  v_add_f32_dpp v40, v207, v40 quad_perm:[0,1,2,3] row_mask:0xf bank_mask:0x8
  v_add_f32_dpp v41, v223, v41 quad_perm:[0,1,2,3] row_mask:0xf bank_mask:0x8
  v_add_f32_dpp v42, v239, v42 quad_perm:[0,1,2,3] row_mask:0xf bank_mask:0x8
  v_add_f32_dpp v43, v255, v43 quad_perm:[0,1,2,3] row_mask:0xf bank_mask:0x8
  v_mfma_f32_16x16x32_bf16 v[192:195], v[128:131], v[28:31], 0
  v_mfma_f32_16x16x32_bf16 v[196:199], v[132:135], v[28:31], 0
  v_mfma_f32_16x16x32_bf16 v[200:203], v[136:139], v[28:31], 0
  v_mfma_f32_16x16x32_bf16 v[204:207], v[140:143], v[28:31], 0
  v_mfma_f32_16x16x32_bf16 v[208:211], v[144:147], v[28:31], 0
  v_mfma_f32_16x16x32_bf16 v[212:215], v[148:151], v[28:31], 0
  v_mfma_f32_16x16x32_bf16 v[216:219], v[152:155], v[28:31], 0
  v_mfma_f32_16x16x32_bf16 v[220:223], v[156:159], v[28:31], 0
  v_mfma_f32_16x16x32_bf16 v[224:227], v[160:163], v[28:31], 0
  v_mfma_f32_16x16x32_bf16 v[228:231], v[164:167], v[28:31], 0
  v_mfma_f32_16x16x32_bf16 v[232:235], v[168:171], v[28:31], 0
  v_mfma_f32_16x16x32_bf16 v[236:239], v[172:175], v[28:31], 0
  v_mfma_f32_16x16x32_bf16 v[240:243], v[176:179], v[28:31], 0
  v_mfma_f32_16x16x32_bf16 v[244:247], v[180:183], v[28:31], 0
  v_mfma_f32_16x16x32_bf16 v[248:251], v[184:187], v[28:31], 0
  v_mfma_f32_16x16x32_bf16 v[252:255], v[188:191], v[28:31], 0
  s_nop 2
  v_mov_b32_dpp v44, v192 quad_perm:[0,1,2,3] row_mask:0xf bank_mask:0x1
  v_mov_b32_dpp v45, v208 quad_perm:[0,1,2,3] row_mask:0xf bank_mask:0x1
  v_mov_b32_dpp v46, v224 quad_perm:[0,1,2,3] row_mask:0xf bank_mask:0x1
  v_mov_b32_dpp v47, v240 quad_perm:[0,1,2,3] row_mask:0xf bank_mask:0x1
  v_add_f32_dpp v44, v193, v44 row_ror:12 row_mask:0xf bank_mask:0x1
  v_add_f32_dpp v45, v209, v45 row_ror:12 row_mask:0xf bank_mask:0x1
  v_add_f32_dpp v46, v225, v46 row_ror:12 row_mask:0xf bank_mask:0x1
  v_add_f32_dpp v47, v241, v47 row_ror:12 row_mask:0xf bank_mask:0x1
  v_add_f32_dpp v44, v194, v44 row_ror:8 row_mask:0xf bank_mask:0x1
  v_add_f32_dpp v45, v210, v45 row_ror:8 row_mask:0xf bank_mask:0x1
  v_add_f32_dpp v46, v226, v46 row_ror:8 row_mask:0xf bank_mask:0x1
  v_add_f32_dpp v47, v242, v47 row_ror:8 row_mask:0xf bank_mask:0x1
  v_add_f32_dpp v44, v195, v44 row_ror:4 row_mask:0xf bank_mask:0x1
  v_add_f32_dpp v45, v211, v45 row_ror:4 row_mask:0xf bank_mask:0x1
  v_add_f32_dpp v46, v227, v46 row_ror:4 row_mask:0xf bank_mask:0x1
  v_add_f32_dpp v47, v243, v47 row_ror:4 row_mask:0xf bank_mask:0x1
  v_mov_b32_dpp v44, v196 row_ror:4 row_mask:0xf bank_mask:0x2
  v_mov_b32_dpp v45, v212 row_ror:4 row_mask:0xf bank_mask:0x2
  v_mov_b32_dpp v46, v228 row_ror:4 row_mask:0xf bank_mask:0x2
  v_mov_b32_dpp v47, v244 row_ror:4 row_mask:0xf bank_mask:0x2
  v_add_f32_dpp v44, v197, v44 quad_perm:[0,1,2,3] row_mask:0xf bank_mask:0x2
  v_add_f32_dpp v45, v213, v45 quad_perm:[0,1,2,3] row_mask:0xf bank_mask:0x2
  v_add_f32_dpp v46, v229, v46 quad_perm:[0,1,2,3] row_mask:0xf bank_mask:0x2
  v_add_f32_dpp v47, v245, v47 quad_perm:[0,1,2,3] row_mask:0xf bank_mask:0x2
  v_add_f32_dpp v44, v198, v44 row_ror:12 row_mask:0xf bank_mask:0x2
  v_add_f32_dpp v45, v214, v45 row_ror:12 row_mask:0xf bank_mask:0x2
  v_add_f32_dpp v46, v230, v46 row_ror:12 row_mask:0xf bank_mask:0x2
  v_add_f32_dpp v47, v246, v47 row_ror:12 row_mask:0xf bank_mask:0x2
  v_add_f32_dpp v44, v199, v44 row_ror:8 row_mask:0xf bank_mask:0x2
  v_add_f32_dpp v45, v215, v45 row_ror:8 row_mask:0xf bank_mask:0x2
  v_add_f32_dpp v46, v231, v46 row_ror:8 row_mask:0xf bank_mask:0x2
  v_add_f32_dpp v47, v247, v47 row_ror:8 row_mask:0xf bank_mask:0x2
  v_mov_b32_dpp v44, v200 row_ror:8 row_mask:0xf bank_mask:0x4
  v_mov_b32_dpp v45, v216 row_ror:8 row_mask:0xf bank_mask:0x4
  v_mov_b32_dpp v46, v232 row_ror:8 row_mask:0xf bank_mask:0x4
  v_mov_b32_dpp v47, v248 row_ror:8 row_mask:0xf bank_mask:0x4
  v_add_f32_dpp v44, v201, v44 row_ror:4 row_mask:0xf bank_mask:0x4
  v_add_f32_dpp v45, v217, v45 row_ror:4 row_mask:0xf bank_mask:0x4
  v_add_f32_dpp v46, v233, v46 row_ror:4 row_mask:0xf bank_mask:0x4
  v_add_f32_dpp v47, v249, v47 row_ror:4 row_mask:0xf bank_mask:0x4
  v_add_f32_dpp v44, v202, v44 quad_perm:[0,1,2,3] row_mask:0xf bank_mask:0x4
  v_add_f32_dpp v45, v218, v45 quad_perm:[0,1,2,3] row_mask:0xf bank_mask:0x4
  v_add_f32_dpp v46, v234, v46 quad_perm:[0,1,2,3] row_mask:0xf bank_mask:0x4
  v_add_f32_dpp v47, v250, v47 quad_perm:[0,1,2,3] row_mask:0xf bank_mask:0x4
  v_add_f32_dpp v44, v203, v44 row_ror:12 row_mask:0xf bank_mask:0x4
  v_add_f32_dpp v45, v219, v45 row_ror:12 row_mask:0xf bank_mask:0x4
  v_add_f32_dpp v46, v235, v46 row_ror:12 row_mask:0xf bank_mask:0x4
  v_add_f32_dpp v47, v251, v47 row_ror:12 row_mask:0xf bank_mask:0x4
  v_mov_b32_dpp v44, v204 row_ror:12 row_mask:0xf bank_mask:0x8
  v_mov_b32_dpp v45, v220 row_ror:12 row_mask:0xf bank_mask:0x8
  v_mov_b32_dpp v46, v236 row_ror:12 row_mask:0xf bank_mask:0x8
  v_mov_b32_dpp v47, v252 row_ror:12 row_mask:0xf bank_mask:0x8
  v_add_f32_dpp v44, v205, v44 row_ror:8 row_mask:0xf bank_mask:0x8
  v_add_f32_dpp v45, v221, v45 row_ror:8 row_mask:0xf bank_mask:0x8
  v_add_f32_dpp v46, v237, v46 row_ror:8 row_mask:0xf bank_mask:0x8
  v_add_f32_dpp v47, v253, v47 row_ror:8 row_mask:0xf bank_mask:0x8
  v_add_f32_dpp v44, v206, v44 row_ror:4 row_mask:0xf bank_mask:0x8
  v_add_f32_dpp v45, v222, v45 row_ror:4 row_mask:0xf bank_mask:0x8
  v_add_f32_dpp v46, v238, v46 row_ror:4 row_mask:0xf bank_mask:0x8
  v_add_f32_dpp v47, v254, v47 row_ror:4 row_mask:0xf bank_mask:0x8
  v_add_f32_dpp v44, v207, v44 quad_perm:[0,1,2,3] row_mask:0xf bank_mask:0x8
  v_add_f32_dpp v45, v223, v45 quad_perm:[0,1,2,3] row_mask:0xf bank_mask:0x8
  v_add_f32_dpp v46, v239, v46 quad_perm:[0,1,2,3] row_mask:0xf bank_mask:0x8
  v_add_f32_dpp v47, v255, v47 quad_perm:[0,1,2,3] row_mask:0xf bank_mask:0x8
  v_cvt_pk_bf16_f32 v24, v40, v41
  v_cvt_pk_bf16_f32 v25, v42, v43
  v_cvt_pk_bf16_f32 v26, v44, v45
  v_cvt_pk_bf16_f32 v27, v46, v47
  v_lshlrev_b32 v40, 16, v24
  v_and_b32 v41, 0xffff0000, v24
  v_lshlrev_b32 v42, 16, v25
  v_and_b32 v43, 0xffff0000, v25
  v_lshlrev_b32 v44, 16, v26
  v_and_b32 v45, 0xffff0000, v26
  v_lshlrev_b32 v46, 16, v27
  v_and_b32 v47, 0xffff0000, v27
  v_mul_f32 v40, s95, v40
  v_mul_f32 v41, s95, v41
  v_mul_f32 v42, s95, v42
  v_mul_f32 v43, s95, v43
  v_mul_f32 v44, s95, v44
  v_mul_f32 v45, s95, v45
  v_mul_f32 v46, s95, v46
  v_mul_f32 v47, s95, v47
  v_cvt_pk_bf16_f32 v24, v40, v41
  v_cvt_pk_bf16_f32 v25, v42, v43
  v_cvt_pk_bf16_f32 v26, v44, v45
  v_cvt_pk_bf16_f32 v27, v46, v47
  v_lshlrev_b32 v40, 16, v24
  v_and_b32 v41, 0xffff0000, v24
  v_lshlrev_b32 v42, 16, v25
  v_and_b32 v43, 0xffff0000, v25
  v_lshlrev_b32 v44, 16, v26
  v_and_b32 v45, 0xffff0000, v26
  v_lshlrev_b32 v46, 16, v27
  v_and_b32 v47, 0xffff0000, v27
  v_max3_f32 v14, v40, v41, v42
  v_max3_f32 v15, v43, v44, v45
  v_max3_f32 v14, v14, v46, v47
  v_max_f32 v14, v14, v15
  s_nop 1
  v_max_f32_dpp v14, v14, v14 row_ror:4 row_mask:0xf bank_mask:0xf
  s_nop 1
  v_max_f32_dpp v14, v14, v14 row_ror:8 row_mask:0xf bank_mask:0xf
  v_mov_b32 v15, v14
  s_nop 1
  v_permlane16_swap_b32 v14, v15
  v_max_f32 v14, v14, v15
  v_mov_b32 v15, v14
  s_nop 1
  v_permlane32_swap_b32 v14, v15
  v_max_f32 v14, v14, v15
  s_mov_b64 exec, 0xf
  ds_write_b32 v23, v14
  s_mov_b64 exec, -1
  s_lshl_b32 s3, s52, 2
  s_add_u32 s3, s3, 0x27620
  v_mov_b32 v13, s3
  v_mov_b32 v14, 1
  ds_write_b32 v13, v14
  v_mov_b32 v13, 0x27620
L_spin3:
  ds_read_b128 v[24:27], v13
  s_waitcnt lgkmcnt(0)
  v_cmp_ne_u32 vcc, 1, v24
  v_cmp_ne_u32 s[62:63], 1, v25
  s_or_b64 vcc, vcc, s[62:63]
  v_cmp_ne_u32 s[62:63], 1, v26
  s_or_b64 vcc, vcc, s[62:63]
  v_cmp_ne_u32 s[62:63], 1, v27
  s_or_b64 vcc, vcc, s[62:63]
  s_cbranch_vccz L_spin3_ok
  s_sub_u32 s61, s61, 1
  s_cbranch_scc1 L_end
  s_branch L_spin3
L_spin3_ok:
  ds_read_b128 v[24:27], v22
  s_waitcnt lgkmcnt(0)
  v_max3_f32 v14, v24, v25, v26
  v_max_f32 v56, v14, v27
  v_mul_f32 v15, s94, v56
  v_fma_f32 v40, v40, s94, -v15
  v_fma_f32 v41, v41, s94, -v15
  v_fma_f32 v42, v42, s94, -v15
  v_fma_f32 v43, v43, s94, -v15
  v_fma_f32 v44, v44, s94, -v15
  v_fma_f32 v45, v45, s94, -v15
  v_fma_f32 v46, v46, s94, -v15
  v_fma_f32 v47, v47, s94, -v15
  v_exp_f32 v40, v40
  v_exp_f32 v41, v41
  v_exp_f32 v42, v42
  v_exp_f32 v43, v43
  v_exp_f32 v44, v44
  v_exp_f32 v45, v45
  v_exp_f32 v46, v46
  v_exp_f32 v47, v47
  s_nop 0
  v_cvt_pk_bf16_f32 v24, v40, v41
  v_cvt_pk_bf16_f32 v25, v42, v43
  v_cvt_pk_bf16_f32 v26, v44, v45
  v_cvt_pk_bf16_f32 v27, v46, v47
  v_add_f32 v40, v40, v44
  v_add_f32 v41, v41, v45
  v_add_f32 v42, v42, v46
  v_add_f32 v43, v43, v47
  v_add_u32 v28, 0, v20
  v_and_b32 v28, 15, v28
  v_lshl_add_u32 v28, v28, 8, v19
  ds_write_b16 v28, v24
  v_add_u32 v29, 2, v20
  v_and_b32 v29, 15, v29
  v_lshl_add_u32 v29, v29, 8, v19
  ds_write_b16_d16_hi v29, v24
  v_add_u32 v28, 4, v20
  v_and_b32 v28, 15, v28
  v_lshl_add_u32 v28, v28, 8, v19
  ds_write_b16 v28, v25
  v_add_u32 v29, 6, v20
  v_and_b32 v29, 15, v29
  v_lshl_add_u32 v29, v29, 8, v19
  ds_write_b16_d16_hi v29, v25
  v_add_u32 v28, 8, v20
  v_and_b32 v28, 15, v28
  v_lshl_add_u32 v28, v28, 8, v19
  ds_write_b16 v28, v26
  v_add_u32 v29, 10, v20
  v_and_b32 v29, 15, v29
  v_lshl_add_u32 v29, v29, 8, v19
  ds_write_b16_d16_hi v29, v26
  v_add_u32 v28, 12, v20
  v_and_b32 v28, 15, v28
  v_lshl_add_u32 v28, v28, 8, v19
  ds_write_b16 v28, v27
  v_add_u32 v29, 14, v20
  v_and_b32 v29, 15, v29
  v_lshl_add_u32 v29, v29, 8, v19
  ds_write_b16_d16_hi v29, v27
  v_add_f32 v40, v40, v41
  v_add_f32 v42, v42, v43
  v_add_f32 v14, v40, v42
  s_nop 1
  v_add_f32_dpp v14, v14, v14 row_ror:4 row_mask:0xf bank_mask:0xf
  s_nop 1
  v_add_f32_dpp v14, v14, v14 row_ror:8 row_mask:0xf bank_mask:0xf
  v_mov_b32 v15, v14
  s_nop 1
  v_permlane16_swap_b32 v14, v15
  v_add_f32 v14, v14, v15
  v_mov_b32 v15, v14
  s_nop 1
  v_permlane32_swap_b32 v14, v15
  v_add_f32 v14, v14, v15
  s_mov_b64 exec, 0xf
  ds_write_b32 v23, v14 offset:64
  s_mov_b64 exec, -1
  s_waitcnt lgkmcnt(0)
  s_barrier
  s_cmp_lg_u32 s52, 0
  s_cbranch_scc1 L_join1
  ds_read_b128 v[24:27], v22 offset:64
  v_mov_b32 v14, 0x27630
  ds_read_b32 v14, v14
  v_lshlrev_b32 v13, 4, v3
  s_lshl_b32 s90, s96, 6
  s_add_u32 s90, s90, 0x20000
  s_waitcnt lgkmcnt(0)
  v_readfirstlane_b32 s101, v14
  v_add_f32 v24, v24, v25
  v_add_f32 v26, v26, v27
  v_add_f32 v26, v24, v26
  v_mov_b32 v24, v56
  v_mov_b32 v25, s59
  v_mov_b32 v27, s59
  s_mov_b64 exec, 0xf
  s_cmp_eq_u32 s101, 1
  s_cbranch_scc1 L_gs4_f
  buffer_store_dwordx4 v[24:27], v13, s[48:51], s90 offen sc1
  s_branch L_gs4_e
L_gs4_f:
  buffer_store_dwordx4 v[24:27], v13, s[48:51], s90 offen
L_gs4_e:
  s_mov_b64 exec, -1
  s_branch L_join1
L_A:
  s_setprio 3
  s_and_b32 s87, s59, 0xff
  v_mov_b32 v59, 0xffffff00
  v_lshlrev_b32 v16, 10, v2
  v_lshl_add_u32 v16, v3, 4, v16
  s_cmp_eq_u32 s52, 7
  s_cbranch_scc1 L_A7
  v_cmp_eq_u32 s[4:5], 1, v2
  v_cmp_eq_u32 s[6:7], 2, v2
  v_cmp_eq_u32 s[98:99], 3, v2
  v_lshrrev_b32 v13, 2, v1
  v_and_b32 v15, 3, v1
  v_lshlrev_b32 v15, 3, v15
  v_lshl_add_u32 v13, v13, 7, v15
  v_lshrrev_b32 v14, 3, v1
  v_and_b32 v14, 3, v14
  v_xor_b32 v20, 0, v14
  v_lshl_add_u32 v20, v20, 5, v13
  v_xor_b32 v21, 1, v14
  v_lshl_add_u32 v21, v21, 5, v13
  v_xor_b32 v22, 2, v14
  v_lshl_add_u32 v22, v22, 5, v13
  v_xor_b32 v23, 3, v14
  v_lshl_add_u32 v23, v23, 5, v13
  v_and_b32 v14, 3, v3
  v_lshlrev_b32 v19, 10, v14
  v_lshl_add_u32 v19, v2, 3, v19
  s_cmp_eq_u32 s52, 5
  s_cbranch_scc0 L_A6
  s_lshl_b32 s3, s55, 8
  s_add_u32 s3, s3, 0x24000
  v_add_u32 v19, s3, v19
  v_add_u32 v20, 0x20000, v20
  v_add_u32 v21, 0x20000, v21
  v_add_u32 v22, 0x20000, v22
  v_add_u32 v23, 0x20000, v23
  v_lshlrev_b32 v18, 8, v2
  v_lshl_add_u32 v18, v3, 2, v18
  v_add_u32 v18, 0x27800, v18
  v_add_u32 v17, 0x27800, v10
  s_lshl_b32 s3, s53, 3
  s_add_u32 s3, s3, s56
  s_lshl_b32 s90, s3, 12
  s_lshl_b32 s3, s55, 8
  s_add_u32 s90, s90, s3
  s_add_u32 s90, s90, 0x200000
  v_mov_b32 v13, 0x27600
L_spin5:
  ds_read_b32 v24, v13
  s_waitcnt lgkmcnt(0)
  v_cmp_ne_u32 vcc, 1, v24
  s_cbranch_vccz L_spin5_ok
  s_sub_u32 s61, s61, 1
  s_cbranch_scc1 L_end
  s_sleep 1
  s_branch L_spin5
L_spin5_ok:
  ds_read2_b64 v[128:131], v19 offset0:0 offset1:4
  ds_read2_b64 v[132:135], v19 offset0:8 offset1:12
  ds_read2_b64 v[136:139], v19 offset0:16 offset1:20
  ds_read2_b64 v[140:143], v19 offset0:24 offset1:28
  ds_read_b64_tr_b16 v[144:145], v20 offset:0
  ds_read_b64_tr_b16 v[146:147], v20 offset:2048
  ds_read_b64_tr_b16 v[148:149], v20 offset:4096
  ds_read_b64_tr_b16 v[150:151], v20 offset:6144
  ds_read_b64_tr_b16 v[152:153], v20 offset:8192
  ds_read_b64_tr_b16 v[154:155], v20 offset:10240
  ds_read_b64_tr_b16 v[156:157], v20 offset:12288
  ds_read_b64_tr_b16 v[158:159], v20 offset:14336
  ds_read_b64_tr_b16 v[160:161], v21 offset:0
  ds_read_b64_tr_b16 v[162:163], v21 offset:2048
  ds_read_b64_tr_b16 v[164:165], v21 offset:4096
  ds_read_b64_tr_b16 v[166:167], v21 offset:6144
  ds_read_b64_tr_b16 v[168:169], v21 offset:8192
  ds_read_b64_tr_b16 v[170:171], v21 offset:10240
  ds_read_b64_tr_b16 v[172:173], v21 offset:12288
  ds_read_b64_tr_b16 v[174:175], v21 offset:14336
  s_waitcnt lgkmcnt(8)
  v_mfma_f32_16x16x32_bf16 v[192:195], v[128:131], v[144:147], 0
  v_mfma_f32_16x16x32_bf16 v[192:195], v[132:135], v[148:151], v[192:195]
  v_mfma_f32_16x16x32_bf16 v[192:195], v[136:139], v[152:155], v[192:195]
  v_mfma_f32_16x16x32_bf16 v[192:195], v[140:143], v[156:159], v[192:195]
  ds_read_b64_tr_b16 v[144:145], v22 offset:0
  ds_read_b64_tr_b16 v[146:147], v22 offset:2048
  ds_read_b64_tr_b16 v[148:149], v22 offset:4096
  ds_read_b64_tr_b16 v[150:151], v22 offset:6144
  ds_read_b64_tr_b16 v[152:153], v22 offset:8192
  ds_read_b64_tr_b16 v[154:155], v22 offset:10240
  ds_read_b64_tr_b16 v[156:157], v22 offset:12288
  ds_read_b64_tr_b16 v[158:159], v22 offset:14336
  s_waitcnt lgkmcnt(8)
  v_mfma_f32_16x16x32_bf16 v[196:199], v[128:131], v[160:163], 0
  v_mfma_f32_16x16x32_bf16 v[196:199], v[132:135], v[164:167], v[196:199]
  v_mfma_f32_16x16x32_bf16 v[196:199], v[136:139], v[168:171], v[196:199]
  v_mfma_f32_16x16x32_bf16 v[196:199], v[140:143], v[172:175], v[196:199]
  ds_read_b64_tr_b16 v[160:161], v23 offset:0
  ds_read_b64_tr_b16 v[162:163], v23 offset:2048
  ds_read_b64_tr_b16 v[164:165], v23 offset:4096
  ds_read_b64_tr_b16 v[166:167], v23 offset:6144
  ds_read_b64_tr_b16 v[168:169], v23 offset:8192
  ds_read_b64_tr_b16 v[170:171], v23 offset:10240
  ds_read_b64_tr_b16 v[172:173], v23 offset:12288
  ds_read_b64_tr_b16 v[174:175], v23 offset:14336
  s_waitcnt lgkmcnt(8)
  v_mfma_f32_16x16x32_bf16 v[200:203], v[128:131], v[144:147], 0
  v_mfma_f32_16x16x32_bf16 v[200:203], v[132:135], v[148:151], v[200:203]
  v_mfma_f32_16x16x32_bf16 v[200:203], v[136:139], v[152:155], v[200:203]
  v_mfma_f32_16x16x32_bf16 v[200:203], v[140:143], v[156:159], v[200:203]
  s_waitcnt lgkmcnt(0)
  v_mfma_f32_16x16x32_bf16 v[204:207], v[128:131], v[160:163], 0
  v_mfma_f32_16x16x32_bf16 v[204:207], v[132:135], v[164:167], v[204:207]
  v_mfma_f32_16x16x32_bf16 v[204:207], v[136:139], v[168:171], v[204:207]
  v_mfma_f32_16x16x32_bf16 v[204:207], v[140:143], v[172:175], v[204:207]
  v_cndmask_b32 v24, v192, v193, s[4:5]
  v_cndmask_b32 v24, v24, v194, s[6:7]
  v_cndmask_b32 v24, v24, v195, s[98:99]
  ds_write_b32 v18, v24 offset:0
  v_cndmask_b32 v25, v196, v197, s[4:5]
  v_cndmask_b32 v25, v25, v198, s[6:7]
  v_cndmask_b32 v25, v25, v199, s[98:99]
  ds_write_b32 v18, v25 offset:64
  v_cndmask_b32 v26, v200, v201, s[4:5]
  v_cndmask_b32 v26, v26, v202, s[6:7]
  v_cndmask_b32 v26, v26, v203, s[98:99]
  ds_write_b32 v18, v26 offset:128
  s_nop 3
  v_cndmask_b32 v27, v204, v205, s[4:5]
  v_cndmask_b32 v27, v27, v206, s[6:7]
  v_cndmask_b32 v27, v27, v207, s[98:99]
  ds_write_b32 v18, v27 offset:192
  s_waitcnt lgkmcnt(0)
  ds_read_b128 v[24:27], v17
  s_waitcnt lgkmcnt(0)
  v_mov_b32 v58, s87
  v_add_u32 v24, 0x80, v24
  v_add_u32 v25, 0x80, v25
  v_add_u32 v26, 0x80, v26
  v_add_u32 v27, 0x80, v27
  v_and_or_b32 v24, v24, v59, v58
  v_and_or_b32 v25, v25, v59, v58
  v_and_or_b32 v26, v26, v59, v58
  v_and_or_b32 v27, v27, v59, v58
  buffer_store_dwordx4 v[24:27], v16, s[48:51], s90 offen sc1
  v_lshlrev_b32 v13, 3, v1
  v_add_u32 v13, 0x27a00, v13
  v_mov_b32 v14, 0
  v_mov_b32 v15, 0
  ds_write_b64 v13, v[14:15]
  s_branch L_qpoll
L_A6:
  s_and_b32 s93, s75, 1
  s_lshl_b32 s93, s93, 2
  s_add_u32 s93, s93, s58
  s_lshl_b32 s3, s93, 7
  s_add_u32 s3, s3, 0x24000
  v_add_u32 v19, s3, v19
  v_add_u32 v20, 0x18000, v20
  v_add_u32 v21, 0x18000, v21
  v_add_u32 v22, 0x18000, v22
  v_add_u32 v23, 0x18000, v23
  v_lshlrev_b32 v18, 9, v2
  v_lshl_add_u32 v18, v3, 2, v18
  v_add_u32 v18, 0x26000, v18
  v_lshrrev_b32 v13, 5, v1
  v_and_b32 v14, 31, v1
  v_lshlrev_b32 v17, 9, v13
  v_lshl_add_u32 v17, v14, 4, v17
  v_add_u32 v17, 0x26000, v17
  v_lshlrev_b32 v16, 12, v13
  v_lshl_add_u32 v16, v14, 4, v16
  s_lshr_b32 s3, s75, 1
  s_lshl_b32 s90, s3, 14
  s_lshl_b32 s3, s93, 9
  s_add_u32 s90, s90, s3
  s_add_u32 s90, s90, 0x280000
  s_add_u32 s91, s90, 8192
  v_mov_b32 v13, 0x27604
L_spin6:
  ds_read_b32 v24, v13
  s_waitcnt lgkmcnt(0)
  v_cmp_ne_u32 vcc, 1, v24
  s_cbranch_vccz L_spin6_ok
  s_sub_u32 s61, s61, 1
  s_cbranch_scc1 L_end
  s_sleep 1
  s_branch L_spin6
L_spin6_ok:
  ds_read2_b64 v[128:131], v19 offset0:0 offset1:4
  ds_read2_b64 v[132:135], v19 offset0:8 offset1:12
  ds_read_b64_tr_b16 v[144:145], v20 offset:0
  ds_read_b64_tr_b16 v[146:147], v20 offset:2048
  ds_read_b64_tr_b16 v[148:149], v20 offset:4096
  ds_read_b64_tr_b16 v[150:151], v20 offset:6144
  ds_read_b64_tr_b16 v[152:153], v21 offset:0
  ds_read_b64_tr_b16 v[154:155], v21 offset:2048
  ds_read_b64_tr_b16 v[156:157], v21 offset:4096
  ds_read_b64_tr_b16 v[158:159], v21 offset:6144
  s_waitcnt lgkmcnt(4)
  v_mfma_f32_16x16x32_bf16 v[192:195], v[128:131], v[144:147], 0
  v_mfma_f32_16x16x32_bf16 v[192:195], v[132:135], v[148:151], v[192:195]
  ds_read_b64_tr_b16 v[144:145], v22 offset:0
  ds_read_b64_tr_b16 v[146:147], v22 offset:2048
  ds_read_b64_tr_b16 v[148:149], v22 offset:4096
  ds_read_b64_tr_b16 v[150:151], v22 offset:6144
  s_waitcnt lgkmcnt(4)
  v_mfma_f32_16x16x32_bf16 v[196:199], v[128:131], v[152:155], 0
  v_mfma_f32_16x16x32_bf16 v[196:199], v[132:135], v[156:159], v[196:199]
  ds_read_b64_tr_b16 v[152:153], v23 offset:0
  ds_read_b64_tr_b16 v[154:155], v23 offset:2048
  ds_read_b64_tr_b16 v[156:157], v23 offset:4096
  ds_read_b64_tr_b16 v[158:159], v23 offset:6144
  s_waitcnt lgkmcnt(4)
  v_mfma_f32_16x16x32_bf16 v[200:203], v[128:131], v[144:147], 0
  v_mfma_f32_16x16x32_bf16 v[200:203], v[132:135], v[148:151], v[200:203]
  ds_read_b64_tr_b16 v[144:145], v20 offset:8192
  ds_read_b64_tr_b16 v[146:147], v20 offset:10240
  ds_read_b64_tr_b16 v[148:149], v20 offset:12288
  ds_read_b64_tr_b16 v[150:151], v20 offset:14336
  s_waitcnt lgkmcnt(4)
  v_mfma_f32_16x16x32_bf16 v[204:207], v[128:131], v[152:155], 0
  v_mfma_f32_16x16x32_bf16 v[204:207], v[132:135], v[156:159], v[204:207]
  ds_read_b64_tr_b16 v[152:153], v21 offset:8192
  ds_read_b64_tr_b16 v[154:155], v21 offset:10240
  ds_read_b64_tr_b16 v[156:157], v21 offset:12288
  ds_read_b64_tr_b16 v[158:159], v21 offset:14336
  s_waitcnt lgkmcnt(4)
  v_mfma_f32_16x16x32_bf16 v[208:211], v[128:131], v[144:147], 0
  v_mfma_f32_16x16x32_bf16 v[208:211], v[132:135], v[148:151], v[208:211]
  ds_read_b64_tr_b16 v[144:145], v22 offset:8192
  ds_read_b64_tr_b16 v[146:147], v22 offset:10240
  ds_read_b64_tr_b16 v[148:149], v22 offset:12288
  ds_read_b64_tr_b16 v[150:151], v22 offset:14336
  s_waitcnt lgkmcnt(4)
  v_mfma_f32_16x16x32_bf16 v[212:215], v[128:131], v[152:155], 0
  v_mfma_f32_16x16x32_bf16 v[212:215], v[132:135], v[156:159], v[212:215]
  ds_read_b64_tr_b16 v[152:153], v23 offset:8192
  ds_read_b64_tr_b16 v[154:155], v23 offset:10240
  ds_read_b64_tr_b16 v[156:157], v23 offset:12288
  ds_read_b64_tr_b16 v[158:159], v23 offset:14336
  s_waitcnt lgkmcnt(4)
  v_mfma_f32_16x16x32_bf16 v[216:219], v[128:131], v[144:147], 0
  v_mfma_f32_16x16x32_bf16 v[216:219], v[132:135], v[148:151], v[216:219]
  s_waitcnt lgkmcnt(0)
  v_mfma_f32_16x16x32_bf16 v[220:223], v[128:131], v[152:155], 0
  v_mfma_f32_16x16x32_bf16 v[220:223], v[132:135], v[156:159], v[220:223]
  v_cndmask_b32 v24, v192, v193, s[4:5]
  v_cndmask_b32 v24, v24, v194, s[6:7]
  v_cndmask_b32 v24, v24, v195, s[98:99]
  ds_write_b32 v18, v24 offset:0
  v_cndmask_b32 v25, v196, v197, s[4:5]
  v_cndmask_b32 v25, v25, v198, s[6:7]
  v_cndmask_b32 v25, v25, v199, s[98:99]
  ds_write_b32 v18, v25 offset:64
  v_cndmask_b32 v26, v200, v201, s[4:5]
  v_cndmask_b32 v26, v26, v202, s[6:7]
  v_cndmask_b32 v26, v26, v203, s[98:99]
  ds_write_b32 v18, v26 offset:128
  v_cndmask_b32 v27, v204, v205, s[4:5]
  v_cndmask_b32 v27, v27, v206, s[6:7]
  v_cndmask_b32 v27, v27, v207, s[98:99]
  ds_write_b32 v18, v27 offset:192
  v_cndmask_b32 v24, v208, v209, s[4:5]
  v_cndmask_b32 v24, v24, v210, s[6:7]
  v_cndmask_b32 v24, v24, v211, s[98:99]
  ds_write_b32 v18, v24 offset:256
  v_cndmask_b32 v25, v212, v213, s[4:5]
  v_cndmask_b32 v25, v25, v214, s[6:7]
  v_cndmask_b32 v25, v25, v215, s[98:99]
  ds_write_b32 v18, v25 offset:320
  v_cndmask_b32 v26, v216, v217, s[4:5]
  v_cndmask_b32 v26, v26, v218, s[6:7]
  v_cndmask_b32 v26, v26, v219, s[98:99]
  ds_write_b32 v18, v26 offset:384
  s_nop 3
  v_cndmask_b32 v27, v220, v221, s[4:5]
  v_cndmask_b32 v27, v27, v222, s[6:7]
  v_cndmask_b32 v27, v27, v223, s[98:99]
  ds_write_b32 v18, v27 offset:448
  s_waitcnt lgkmcnt(0)
  ds_read_b128 v[24:27], v17
  ds_read_b128 v[28:31], v17 offset:1024
  s_waitcnt lgkmcnt(0)
  v_mov_b32 v58, s87
  v_add_u32 v24, 0x80, v24
  v_add_u32 v25, 0x80, v25
  v_add_u32 v26, 0x80, v26
  v_add_u32 v27, 0x80, v27
  v_add_u32 v28, 0x80, v28
  v_add_u32 v29, 0x80, v29
  v_add_u32 v30, 0x80, v30
  v_add_u32 v31, 0x80, v31
  v_and_or_b32 v24, v24, v59, v58
  v_and_or_b32 v25, v25, v59, v58
  v_and_or_b32 v26, v26, v59, v58
  v_and_or_b32 v27, v27, v59, v58
  v_and_or_b32 v28, v28, v59, v58
  v_and_or_b32 v29, v29, v59, v58
  v_and_or_b32 v30, v30, v59, v58
  v_and_or_b32 v31, v31, v59, v58
  buffer_store_dwordx4 v[24:27], v16, s[48:51], s90 offen sc1
  buffer_store_dwordx4 v[28:31], v16, s[48:51], s91 offen sc1
  s_branch L_fpoll6
L_qpoll:
  v_lshlrev_b32 v20, 12, v2
  v_lshl_add_u32 v20, v3, 4, v20
  s_cmp_eq_u32 s52, 7
  s_cselect_b32 s3, 4, 0
  s_lshl_b32 s90, s53, 3
  s_add_u32 s90, s90, s3
  s_lshl_b32 s90, s90, 12
  s_lshl_b32 s91, s55, 10
  s_add_u32 s90, s90, s91
  s_add_u32 s90, s90, 0x200000
  s_lshl_b32 s3, s3, 7
  s_add_u32 s3, s3, 0x27000
  v_lshlrev_b32 v21, 7, v2
  v_lshl_add_u32 v21, v3, 3, v21
  v_add_u32 v21, s3, v21
  s_sleep 28
L_qpl:
  buffer_load_dwordx4 v[128:131], v20, s[48:51], s90 offen offset:0 sc1
  buffer_load_dwordx4 v[132:135], v20, s[48:51], s90 offen offset:256 sc1
  buffer_load_dwordx4 v[136:139], v20, s[48:51], s90 offen offset:512 sc1
  buffer_load_dwordx4 v[140:143], v20, s[48:51], s90 offen offset:768 sc1
  s_waitcnt vmcnt(0)
  v_mov_b32 v58, s87
  v_xor_b32 v13, v58, v128
  v_xor_b32 v14, v58, v129
  v_xor_b32 v15, v58, v130
  v_or_b32 v13, v13, v15
  v_xor_b32 v15, v58, v131
  v_or_b32 v14, v14, v15
  v_xor_b32 v15, v58, v132
  v_or_b32 v13, v13, v15
  v_xor_b32 v15, v58, v133
  v_or_b32 v14, v14, v15
  v_xor_b32 v15, v58, v134
  v_or_b32 v13, v13, v15
  v_xor_b32 v15, v58, v135
  v_or_b32 v14, v14, v15
  v_xor_b32 v15, v58, v136
  v_or_b32 v13, v13, v15
  v_xor_b32 v15, v58, v137
  v_or_b32 v14, v14, v15
  v_xor_b32 v15, v58, v138
  v_or_b32 v13, v13, v15
  v_xor_b32 v15, v58, v139
  v_or_b32 v14, v14, v15
  v_xor_b32 v15, v58, v140
  v_or_b32 v13, v13, v15
  v_xor_b32 v15, v58, v141
  v_or_b32 v14, v14, v15
  v_xor_b32 v15, v58, v142
  v_or_b32 v13, v13, v15
  v_xor_b32 v15, v58, v143
  v_or_b32 v14, v14, v15
  v_or_b32 v13, v13, v14
  v_and_b32 v13, 0xff, v13
  v_cmp_ne_u32 vcc, 0, v13
  s_cbranch_vccz L_qok
  s_sub_u32 s61, s61, 1
  s_cbranch_scc1 L_end
  s_sleep 2
  s_branch L_qpl
L_qok:
  v_and_b32 v128, v59, v128
  v_and_b32 v129, v59, v129
  v_and_b32 v130, v59, v130
  v_and_b32 v131, v59, v131
  v_and_b32 v132, v59, v132
  v_and_b32 v133, v59, v133
  v_and_b32 v134, v59, v134
  v_and_b32 v135, v59, v135
  v_and_b32 v136, v59, v136
  v_and_b32 v137, v59, v137
  v_and_b32 v138, v59, v138
  v_and_b32 v139, v59, v139
  v_and_b32 v140, v59, v140
  v_and_b32 v141, v59, v141
  v_and_b32 v142, v59, v142
  v_and_b32 v143, v59, v143
  v_add_f32 v40, v128, v132
  v_add_f32 v44, v136, v140
  v_add_f32 v41, v129, v133
  v_add_f32 v45, v137, v141
  v_add_f32 v42, v130, v134
  v_add_f32 v46, v138, v142
  v_add_f32 v43, v131, v135
  v_add_f32 v47, v139, v143
  v_add_f32 v40, v40, v44
  v_add_f32 v41, v41, v45
  v_add_f32 v42, v42, v46
  v_add_f32 v43, v43, v47
  v_cvt_pk_bf16_f32 v40, v40, v41
  v_cvt_pk_bf16_f32 v41, v42, v43
  ds_write_b64 v21, v[40:41]
  s_cmp_eq_u32 s52, 5
  s_cselect_b32 s3, 16, 20
  s_add_u32 s3, s3, 0x27600
  v_mov_b32 v13, s3
  v_mov_b32 v14, 1
  s_waitcnt lgkmcnt(0)
  ds_write_b32 v13, v14
  s_cmp_eq_u32 s52, 5
  s_cbranch_scc1 L_Aend
  s_branch L_xpoll
L_fpoll6:
  v_mov_b32 v13, 0x27618
  v_mov_b32 v14, 1
  s_waitcnt lgkmcnt(0)
  ds_write_b32 v13, v14
  s_lshr_b32 s3, s75, 1
  s_lshl_b32 s90, s3, 14
  s_and_b32 s3, s75, 1
  s_lshl_b32 s3, s3, 7
  s_add_u32 s90, s90, s3
  s_add_u32 s90, s90, 0x280000
  v_lshlrev_b32 v20, 12, v2
  v_lshrrev_b32 v13, 3, v3
  v_lshl_add_u32 v20, v13, 8, v20
  v_and_b32 v13, 7, v3
  v_lshl_add_u32 v20, v13, 4, v20
  s_sleep 84
L_fpl:
  buffer_load_dwordx4 v[128:131], v20, s[48:51], s90 offen offset:0 sc1
  buffer_load_dwordx4 v[132:135], v20, s[48:51], s90 offen offset:512 sc1
  buffer_load_dwordx4 v[136:139], v20, s[48:51], s90 offen offset:1024 sc1
  buffer_load_dwordx4 v[140:143], v20, s[48:51], s90 offen offset:1536 sc1
  buffer_load_dwordx4 v[144:147], v20, s[48:51], s90 offen offset:2048 sc1
  buffer_load_dwordx4 v[148:151], v20, s[48:51], s90 offen offset:2560 sc1
  buffer_load_dwordx4 v[152:155], v20, s[48:51], s90 offen offset:3072 sc1
  buffer_load_dwordx4 v[156:159], v20, s[48:51], s90 offen offset:3584 sc1
  s_waitcnt vmcnt(0)
  v_mov_b32 v58, s87
  v_xor_b32 v13, v58, v128
  v_xor_b32 v14, v58, v129
  v_xor_b32 v15, v58, v130
  v_or_b32 v13, v13, v15
  v_xor_b32 v15, v58, v131
  v_or_b32 v14, v14, v15
  v_xor_b32 v15, v58, v132
  v_or_b32 v13, v13, v15
  v_xor_b32 v15, v58, v133
  v_or_b32 v14, v14, v15
  v_xor_b32 v15, v58, v134
  v_or_b32 v13, v13, v15
  v_xor_b32 v15, v58, v135
  v_or_b32 v14, v14, v15
  v_xor_b32 v15, v58, v136
  v_or_b32 v13, v13, v15
  v_xor_b32 v15, v58, v137
  v_or_b32 v14, v14, v15
  v_xor_b32 v15, v58, v138
  v_or_b32 v13, v13, v15
  v_xor_b32 v15, v58, v139
  v_or_b32 v14, v14, v15
  v_xor_b32 v15, v58, v140
  v_or_b32 v13, v13, v15
  v_xor_b32 v15, v58, v141
  v_or_b32 v14, v14, v15
  v_xor_b32 v15, v58, v142
  v_or_b32 v13, v13, v15
  v_xor_b32 v15, v58, v143
  v_or_b32 v14, v14, v15
  v_xor_b32 v15, v58, v144
  v_or_b32 v13, v13, v15
  v_xor_b32 v15, v58, v145
  v_or_b32 v14, v14, v15
  v_xor_b32 v15, v58, v146
  v_or_b32 v13, v13, v15
  v_xor_b32 v15, v58, v147
  v_or_b32 v14, v14, v15
  v_xor_b32 v15, v58, v148
  v_or_b32 v13, v13, v15
  v_xor_b32 v15, v58, v149
  v_or_b32 v14, v14, v15
  v_xor_b32 v15, v58, v150
  v_or_b32 v13, v13, v15
  v_xor_b32 v15, v58, v151
  v_or_b32 v14, v14, v15
  v_xor_b32 v15, v58, v152
  v_or_b32 v13, v13, v15
  v_xor_b32 v15, v58, v153
  v_or_b32 v14, v14, v15
  v_xor_b32 v15, v58, v154
  v_or_b32 v13, v13, v15
  v_xor_b32 v15, v58, v155
  v_or_b32 v14, v14, v15
  v_xor_b32 v15, v58, v156
  v_or_b32 v13, v13, v15
  v_xor_b32 v15, v58, v157
  v_or_b32 v14, v14, v15
  v_xor_b32 v15, v58, v158
  v_or_b32 v13, v13, v15
  v_xor_b32 v15, v58, v159
  v_or_b32 v14, v14, v15
  v_or_b32 v13, v13, v14
  v_and_b32 v13, 0xff, v13
  v_cmp_ne_u32 vcc, 0, v13
  s_cbranch_vccz L_fok2
  s_sub_u32 s61, s61, 1
  s_cbranch_scc1 L_end
  s_sleep 2
  s_branch L_fpl
L_fok2:
  v_and_b32 v144, v59, v144
  v_and_b32 v145, v59, v145
  v_and_b32 v146, v59, v146
  v_and_b32 v147, v59, v147
  v_and_b32 v148, v59, v148
  v_and_b32 v149, v59, v149
  v_and_b32 v150, v59, v150
  v_and_b32 v151, v59, v151
  v_and_b32 v152, v59, v152
  v_and_b32 v153, v59, v153
  v_and_b32 v154, v59, v154
  v_and_b32 v155, v59, v155
  v_and_b32 v156, v59, v156
  v_and_b32 v157, v59, v157
  v_and_b32 v158, v59, v158
  v_and_b32 v159, v59, v159
  v_and_b32 v128, v59, v128
  v_and_b32 v129, v59, v129
  v_and_b32 v130, v59, v130
  v_and_b32 v131, v59, v131
  v_and_b32 v132, v59, v132
  v_and_b32 v133, v59, v133
  v_and_b32 v134, v59, v134
  v_and_b32 v135, v59, v135
  v_and_b32 v136, v59, v136
  v_and_b32 v137, v59, v137
  v_and_b32 v138, v59, v138
  v_and_b32 v139, v59, v139
  v_and_b32 v140, v59, v140
  v_and_b32 v141, v59, v141
  v_and_b32 v142, v59, v142
  v_and_b32 v143, v59, v143
  v_add_f32 v128, v128, v144
  v_add_f32 v129, v129, v145
  v_add_f32 v130, v130, v146
  v_add_f32 v131, v131, v147
  v_add_f32 v132, v132, v148
  v_add_f32 v133, v133, v149
  v_add_f32 v134, v134, v150
  v_add_f32 v135, v135, v151
  v_add_f32 v136, v136, v152
  v_add_f32 v137, v137, v153
  v_add_f32 v138, v138, v154
  v_add_f32 v139, v139, v155
  v_add_f32 v140, v140, v156
  v_add_f32 v141, v141, v157
  v_add_f32 v142, v142, v158
  v_add_f32 v143, v143, v159
  v_and_b32 v128, v59, v128
  v_and_b32 v129, v59, v129
  v_and_b32 v130, v59, v130
  v_and_b32 v131, v59, v131
  v_and_b32 v132, v59, v132
  v_and_b32 v133, v59, v133
  v_and_b32 v134, v59, v134
  v_and_b32 v135, v59, v135
  v_and_b32 v136, v59, v136
  v_and_b32 v137, v59, v137
  v_and_b32 v138, v59, v138
  v_and_b32 v139, v59, v139
  v_and_b32 v140, v59, v140
  v_and_b32 v141, v59, v141
  v_and_b32 v142, v59, v142
  v_and_b32 v143, v59, v143
  v_add_f32 v40, v128, v132
  v_add_f32 v44, v136, v140
  v_add_f32 v41, v129, v133
  v_add_f32 v45, v137, v141
  v_add_f32 v42, v130, v134
  v_add_f32 v46, v138, v142
  v_add_f32 v43, v131, v135
  v_add_f32 v47, v139, v143
  v_add_f32 v40, v40, v44
  v_add_f32 v41, v41, v45
  v_add_f32 v42, v42, v46
  v_add_f32 v43, v43, v47
  s_nop 0
  v_mov_b32_dpp v44, v40 row_ror:8 row_mask:0xf bank_mask:0xf
  v_mov_b32_dpp v45, v41 row_ror:8 row_mask:0xf bank_mask:0xf
  v_mov_b32_dpp v46, v42 row_ror:8 row_mask:0xf bank_mask:0xf
  v_mov_b32_dpp v47, v43 row_ror:8 row_mask:0xf bank_mask:0xf
  v_cvt_pk_bf16_f32 v13, v40, v40
  v_lshlrev_b32 v40, 16, v13
  v_cvt_pk_bf16_f32 v14, v41, v41
  v_lshlrev_b32 v41, 16, v14
  v_cvt_pk_bf16_f32 v13, v42, v42
  v_lshlrev_b32 v42, 16, v13
  v_cvt_pk_bf16_f32 v14, v43, v43
  v_lshlrev_b32 v43, 16, v14
  v_cvt_pk_bf16_f32 v13, v44, v44
  v_lshlrev_b32 v44, 16, v13
  v_cvt_pk_bf16_f32 v14, v45, v45
  v_lshlrev_b32 v45, 16, v14
  v_cvt_pk_bf16_f32 v13, v46, v46
  v_lshlrev_b32 v46, 16, v13
  v_cvt_pk_bf16_f32 v14, v47, v47
  v_lshlrev_b32 v47, 16, v14
  v_mul_f32 v40, s94, v40
  v_mul_f32 v41, s94, v41
  v_mul_f32 v42, s94, v42
  v_mul_f32 v43, s94, v43
  v_exp_f32 v40, -v40
  v_exp_f32 v41, -v41
  v_exp_f32 v42, -v42
  v_exp_f32 v43, -v43
  s_nop 0
  v_add_f32 v40, 1.0, v40
  v_add_f32 v41, 1.0, v41
  v_add_f32 v42, 1.0, v42
  v_add_f32 v43, 1.0, v43
  v_rcp_f32 v40, v40
  v_rcp_f32 v41, v41
  v_rcp_f32 v42, v42
  v_rcp_f32 v43, v43
  v_and_b32 v15, 3, v3
  v_lshlrev_b32 v15, 4, v15
  v_lshrrev_b32 v14, 2, v3
  v_lshl_add_u32 v15, v14, 3, v15
  v_lshl_add_u32 v15, v2, 6, v15
  v_add_u32 v15, 0x27400, v15
  v_cvt_pk_bf16_f32 v13, v40, v40
  v_lshlrev_b32 v40, 16, v13
  v_cvt_pk_bf16_f32 v14, v41, v41
  v_lshlrev_b32 v41, 16, v14
  v_cvt_pk_bf16_f32 v13, v42, v42
  v_lshlrev_b32 v42, 16, v13
  v_cvt_pk_bf16_f32 v14, v43, v43
  v_lshlrev_b32 v43, 16, v14
  v_mul_f32 v40, v40, v44
  v_mul_f32 v41, v41, v45
  v_mul_f32 v42, v42, v46
  v_mul_f32 v43, v43, v47
  v_cvt_pk_bf16_f32 v40, v40, v41
  v_cvt_pk_bf16_f32 v41, v42, v43
  s_mov_b32 exec_lo, 0x00ff00ff
  s_mov_b32 exec_hi, 0x00ff00ff
  ds_write_b64 v15, v[40:41]
  s_mov_b64 exec, -1
  s_branch L_Aend
L_A7:
  v_mov_b32 v22, s100
  v_mov_b32 v23, s59
  s_lshl_b32 s3, s53, 8
  s_lshl_b32 s7, s54, 3
  s_add_u32 s3, s3, s7
  s_add_u32 s3, s3, 0x30000
  v_mov_b32 v13, 0
  s_mov_b64 exec, 1
  buffer_store_dwordx2 v[22:23], v13, s[48:51], s3 offen sc1
  s_mov_b64 exec, -1
  buffer_load_dwordx4 v[28:31], v10, s[40:43], 0 offen
  v_mov_b32 v13, 0x27600
L_spin7:
  ds_read_b32 v24, v13
  s_waitcnt lgkmcnt(0)
  v_cmp_ne_u32 vcc, 1, v24
  s_cbranch_vccz L_spin7_ok
  s_sub_u32 s61, s61, 1
  s_cbranch_scc1 L_end
  s_sleep 1
  s_branch L_spin7
L_spin7_ok:
  v_add_u32 v13, 0x24000, v10
  ds_read_b128 v[128:131], v13 offset:0
  ds_read_b128 v[132:135], v13 offset:1024
  ds_read_b128 v[136:139], v13 offset:2048
  ds_read_b128 v[140:143], v13 offset:3072
  v_mov_b32 v40, 0
  v_mov_b32 v41, 0
  v_mov_b32 v42, 0
  v_mov_b32 v43, 0
  s_waitcnt vmcnt(0) lgkmcnt(0)
  v_dot2c_f32_bf16 v40, v128, v28
  v_dot2c_f32_bf16 v41, v132, v28
  v_dot2c_f32_bf16 v42, v136, v28
  v_dot2c_f32_bf16 v43, v140, v28
  v_dot2c_f32_bf16 v40, v129, v29
  v_dot2c_f32_bf16 v41, v133, v29
  v_dot2c_f32_bf16 v42, v137, v29
  v_dot2c_f32_bf16 v43, v141, v29
  v_dot2c_f32_bf16 v40, v130, v30
  v_dot2c_f32_bf16 v41, v134, v30
  v_dot2c_f32_bf16 v42, v138, v30
  v_dot2c_f32_bf16 v43, v142, v30
  v_dot2c_f32_bf16 v40, v131, v31
  v_dot2c_f32_bf16 v41, v135, v31
  v_dot2c_f32_bf16 v42, v139, v31
  v_dot2c_f32_bf16 v43, v143, v31
  s_nop 2
  v_add_f32_dpp v40, v40, v40 quad_perm:[1,0,3,2] row_mask:0xf bank_mask:0xf
  v_add_f32_dpp v41, v41, v41 quad_perm:[1,0,3,2] row_mask:0xf bank_mask:0xf
  v_add_f32_dpp v42, v42, v42 quad_perm:[1,0,3,2] row_mask:0xf bank_mask:0xf
  v_add_f32_dpp v43, v43, v43 quad_perm:[1,0,3,2] row_mask:0xf bank_mask:0xf
  v_add_f32_dpp v40, v40, v40 quad_perm:[2,3,0,1] row_mask:0xf bank_mask:0xf
  v_add_f32_dpp v41, v41, v41 quad_perm:[2,3,0,1] row_mask:0xf bank_mask:0xf
  v_add_f32_dpp v42, v42, v42 quad_perm:[2,3,0,1] row_mask:0xf bank_mask:0xf
  v_add_f32_dpp v43, v43, v43 quad_perm:[2,3,0,1] row_mask:0xf bank_mask:0xf
  v_add_f32_dpp v40, v40, v40 row_half_mirror row_mask:0xf bank_mask:0xf
  v_add_f32_dpp v41, v41, v41 row_half_mirror row_mask:0xf bank_mask:0xf
  v_add_f32_dpp v42, v42, v42 row_half_mirror row_mask:0xf bank_mask:0xf
  v_add_f32_dpp v43, v43, v43 row_half_mirror row_mask:0xf bank_mask:0xf
  v_add_f32_dpp v40, v40, v40 row_mirror row_mask:0xf bank_mask:0xf
  v_add_f32_dpp v41, v41, v41 row_mirror row_mask:0xf bank_mask:0xf
  v_add_f32_dpp v42, v42, v42 row_mirror row_mask:0xf bank_mask:0xf
  v_add_f32_dpp v43, v43, v43 row_mirror row_mask:0xf bank_mask:0xf
  v_mov_b32 v44, v40
  v_mov_b32 v45, v41
  v_mov_b32 v46, v42
  v_mov_b32 v47, v43
  s_nop 1
  v_permlane16_swap_b32 v40, v44
  v_permlane16_swap_b32 v41, v45
  v_permlane16_swap_b32 v42, v46
  v_permlane16_swap_b32 v43, v47
  s_nop 0
  v_add_f32 v40, v40, v44
  v_add_f32 v41, v41, v45
  v_add_f32 v42, v42, v46
  v_add_f32 v43, v43, v47
  v_mov_b32 v44, v40
  v_mov_b32 v45, v41
  v_mov_b32 v46, v42
  v_mov_b32 v47, v43
  s_nop 1
  v_permlane32_swap_b32 v40, v44
  v_permlane32_swap_b32 v41, v45
  v_permlane32_swap_b32 v42, v46
  v_permlane32_swap_b32 v43, v47
  s_nop 0
  v_add_f32 v40, v40, v44
  v_add_f32 v41, v41, v45
  v_add_f32 v42, v42, v46
  v_add_f32 v43, v43, v47
  v_cvt_pk_bf16_f32 v13, v40, v40
  v_lshlrev_b32 v40, 16, v13
  v_cvt_pk_bf16_f32 v13, v41, v41
  v_lshlrev_b32 v41, 16, v13
  v_cvt_pk_bf16_f32 v13, v42, v42
  v_lshlrev_b32 v42, 16, v13
  v_cvt_pk_bf16_f32 v13, v43, v43
  v_lshlrev_b32 v43, 16, v13
  v_mul_f32 v40, s94, v40
  v_mul_f32 v41, s94, v41
  v_mul_f32 v42, s94, v42
  v_mul_f32 v43, s94, v43
  v_exp_f32 v40, -v40
  v_exp_f32 v41, -v41
  v_exp_f32 v42, -v42
  v_exp_f32 v43, -v43
  s_nop 0
  v_add_f32 v40, 1.0, v40
  v_add_f32 v41, 1.0, v41
  v_add_f32 v42, 1.0, v42
  v_add_f32 v43, 1.0, v43
  v_rcp_f32 v40, v40
  v_rcp_f32 v41, v41
  v_rcp_f32 v42, v42
  v_rcp_f32 v43, v43
  s_nop 0
  v_cvt_pk_bf16_f32 v13, v40, v40
  v_lshlrev_b32 v40, 16, v13
  v_cvt_pk_bf16_f32 v13, v41, v41
  v_lshlrev_b32 v41, 16, v13
  v_cvt_pk_bf16_f32 v13, v42, v42
  v_lshlrev_b32 v42, 16, v13
  v_cvt_pk_bf16_f32 v13, v43, v43
  v_lshlrev_b32 v43, 16, v13
  v_sub_f32 v44, 1.0, v40
  v_cvt_pk_bf16_f32 v13, v44, v44
  v_lshlrev_b32 v44, 16, v13
  v_sub_f32 v45, 1.0, v41
  v_cvt_pk_bf16_f32 v13, v45, v45
  v_lshlrev_b32 v45, 16, v13
  v_sub_f32 v46, 1.0, v42
  v_cvt_pk_bf16_f32 v13, v46, v46
  v_lshlrev_b32 v46, 16, v13
  v_sub_f32 v47, 1.0, v43
  v_cvt_pk_bf16_f32 v13, v47, v47
  v_lshlrev_b32 v47, 16, v13
  v_mov_b32 v13, 0x27580
  s_mov_b64 exec, 1
  ds_write_b128 v13, v[40:43]
  ds_write_b128 v13, v[44:47] offset:16
  s_mov_b64 exec, -1
  s_branch L_qpoll
L_xpoll:
  v_and_b32 v13, 31, v1
  v_lshlrev_b32 v62, 3, v13
  s_lshl_b32 s93, s53, 8
  s_add_u32 s93, s93, 0x30000
  s_sleep 8
L_xpl:
  buffer_load_dwordx2 v[60:61], v62, s[48:51], s93 offen sc1
  s_waitcnt vmcnt(0)
  v_cmp_ne_u32 vcc, s59, v61
  s_cbranch_vccz L_xok
  s_sub_u32 s61, s61, 1
  s_cbranch_scc1 L_end
  s_sleep 8
  s_branch L_xpl
L_xok:
  v_cmp_ne_u32 vcc, s100, v60
  s_cmp_eq_u64 vcc, 0
  s_cselect_b32 s3, 1, 0
  v_mov_b32 v13, s3
  v_mov_b32 v14, 0x27630
  ds_write_b32 v14, v13
L_Aend:
  v_lshlrev_b32 v58, 6, v3
  v_lshl_add_u32 v58, v2, 4, v58
  s_lshl_b32 s4, s96, 11
  s_lshl_b32 s3, s52, 8
  s_add_u32 s4, s4, s3
  s_add_u32 s4, s4, 0x40000
  s_lshr_b32 s5, s52, 1
  s_lshl_b32 s5, s5, 3
  s_add_u32 s5, s5, s53
  s_lshl_b32 s5, s5, 3
  s_and_b32 s3, s52, 1
  s_lshl_b32 s3, s3, 2
  s_add_u32 s5, s5, s3
  s_lshl_b32 s5, s5, 11
  s_lshl_b32 s3, s57, 8
  s_add_u32 s5, s5, s3
  s_add_u32 s5, s5, 0x40000
  v_lshlrev_b32 v59, 11, v2
  v_lshl_add_u32 v59, v3, 4, v59
  v_lshrrev_b32 v13, 3, v3
  v_lshlrev_b32 v13, 2, v13
  v_and_b32 v14, 3, v3
  v_add_u32 v13, v13, v14
  s_and_b32 s3, s52, 1
  s_lshl_b32 s3, s3, 2
  v_add_u32 v14, s3, v2
  v_xor_b32 v13, v13, v14
  v_lshlrev_b32 v13, 4, v13
  v_lshrrev_b32 v14, 2, v3
  v_and_b32 v14, 1, v14
  v_lshl_add_u32 v13, v14, 3, v13
  v_lshl_add_u32 v13, v2, 7, v13
  s_lshl_b32 s3, s52, 9
  s_add_u32 s3, s3, 0x26000
  v_add_u32 v60, s3, v13
  v_lshrrev_b32 v13, 2, v3
  v_lshlrev_b32 v13, 2, v13
  v_lshl_add_u32 v13, v2, 4, v13
  s_lshl_b32 s3, s52, 6
  s_add_u32 s3, s3, 0x27800
  v_add_u32 v61, s3, v13
  v_and_b32 v14, 7, v3
  v_xor_b32 v54, v2, v14
  v_xor_b32 v55, 4, v54
  v_lshlrev_b32 v54, 4, v54
  v_lshlrev_b32 v55, 4, v55
  v_lshl_add_u32 v54, v3, 7, v54
  v_lshl_add_u32 v55, v3, 7, v55
  v_add_u32 v54, 0x26000, v54
  v_add_u32 v55, 0x26000, v55
  v_add_u32 v57, 0x20000, v9
  v_lshrrev_b32 v63, 1, v2
  v_lshlrev_b32 v63, 19, v63
  v_lshrrev_b32 v13, 3, v3
  v_lshl_add_u32 v63, v13, 13, v63
  v_and_b32 v13, 7, v3
  v_lshl_add_u32 v63, v13, 4, v63
  s_lshl_b32 s7, s58, 3
  s_lshl_b32 s3, s52, 1
  s_and_b32 s3, s3, 7
  s_add_u32 s7, s7, s3
  s_lshl_b32 s7, s7, 14
  s_lshl_b32 s3, s97, 7
  s_add_u32 s7, s7, s3
  s_add_u32 s7, s7, 0x100000
  s_add_u32 s6, s7, 16384
  v_lshrrev_b32 v47, 5, v1
  v_lshlrev_b32 v47, 12, v47
  v_and_b32 v13, 31, v1
  v_lshl_add_u32 v56, v13, 4, v47
  s_lshl_b32 s93, s53, 9
  s_add_u32 s93, s93, 0x20000
  s_add_u32 s92, s93, 8192
  s_waitcnt lgkmcnt(0)
  s_setprio 0
  s_barrier
L_join1:
  v_and_b32 v13, 3, v3
  v_lshl_add_u32 v13, v2, 2, v13
  v_lshlrev_b32 v13, 4, v13
  v_add_u32 v13, 0x24000, v13
  s_add_u32 s3, s89, 0
  s_and_b32 s3, s3, 15
  s_lshl_b32 s3, s3, 8
  v_add_u32 v14, s3, v13
  ds_read_b128 v[128:131], v14
  s_add_u32 s3, s89, 1
  s_and_b32 s3, s3, 15
  s_lshl_b32 s3, s3, 8
  v_add_u32 v14, s3, v13
  ds_read_b128 v[132:135], v14
  s_add_u32 s3, s89, 2
  s_and_b32 s3, s3, 15
  s_lshl_b32 s3, s3, 8
  v_add_u32 v14, s3, v13
  ds_read_b128 v[136:139], v14
  s_add_u32 s3, s89, 3
  s_and_b32 s3, s3, 15
  s_lshl_b32 s3, s3, 8
  v_add_u32 v14, s3, v13
  ds_read_b128 v[140:143], v14
  s_add_u32 s3, s89, 4
  s_and_b32 s3, s3, 15
  s_lshl_b32 s3, s3, 8
  v_add_u32 v14, s3, v13
  ds_read_b128 v[144:147], v14
  s_add_u32 s3, s89, 5
  s_and_b32 s3, s3, 15
  s_lshl_b32 s3, s3, 8
  v_add_u32 v14, s3, v13
  ds_read_b128 v[148:151], v14
  s_add_u32 s3, s89, 6
  s_and_b32 s3, s3, 15
  s_lshl_b32 s3, s3, 8
  v_add_u32 v14, s3, v13
  ds_read_b128 v[152:155], v14
  s_add_u32 s3, s89, 7
  s_and_b32 s3, s3, 15
  s_lshl_b32 s3, s3, 8
  v_add_u32 v14, s3, v13
  ds_read_b128 v[156:159], v14
  v_add_u32 v14, 0x25000, v9
  ds_read_b64_tr_b16 v[32:33], v14
  ds_read_b64_tr_b16 v[34:35], v14 offset:4096
  v_xor_b32 v14, 32, v14
  ds_read_b64_tr_b16 v[28:29], v14
  ds_read_b64_tr_b16 v[30:31], v14 offset:4096
  v_lshrrev_b32 v14, 3, v3
  v_and_b32 v15, 1, v3
  v_lshl_add_u32 v14, v15, 1, v14
  v_lshlrev_b32 v14, 6, v14
  v_lshl_add_u32 v14, v2, 4, v14
  v_add_u32 v14, 0x27400, v14
  ds_read_b128 v[48:51], v14
  v_lshrrev_b32 v14, 1, v2
  v_lshlrev_b32 v14, 2, v14
  v_add_u32 v14, 0x27590, v14
  ds_read_b32 v52, v14
  ds_read_b32 v53, v14 offset:8
  v_mov_b32 v14, 0x27630
  ds_read_b32 v62, v14
  s_waitcnt lgkmcnt(0)
  s_add_u32 s3, s89, 8
  s_and_b32 s3, s3, 15
  s_lshl_b32 s3, s3, 8
  v_add_u32 v14, s3, v13
  ds_read_b128 v[160:163], v14
  s_add_u32 s3, s89, 9
  s_and_b32 s3, s3, 15
  s_lshl_b32 s3, s3, 8
  v_add_u32 v14, s3, v13
  ds_read_b128 v[164:167], v14
  s_add_u32 s3, s89, 10
  s_and_b32 s3, s3, 15
  s_lshl_b32 s3, s3, 8
  v_add_u32 v14, s3, v13
  ds_read_b128 v[168:171], v14
  s_add_u32 s3, s89, 11
  s_and_b32 s3, s3, 15
  s_lshl_b32 s3, s3, 8
  v_add_u32 v14, s3, v13
  ds_read_b128 v[172:175], v14
  s_add_u32 s3, s89, 12
  s_and_b32 s3, s3, 15
  s_lshl_b32 s3, s3, 8
  v_add_u32 v14, s3, v13
  ds_read_b128 v[176:179], v14
  s_add_u32 s3, s89, 13
  s_and_b32 s3, s3, 15
  s_lshl_b32 s3, s3, 8
  v_add_u32 v14, s3, v13
  ds_read_b128 v[180:183], v14
  s_add_u32 s3, s89, 14
  s_and_b32 s3, s3, 15
  s_lshl_b32 s3, s3, 8
  v_add_u32 v14, s3, v13
  ds_read_b128 v[184:187], v14
  s_add_u32 s3, s89, 15
  s_and_b32 s3, s3, 15
  s_lshl_b32 s3, s3, 8
  v_add_u32 v14, s3, v13
  ds_read_b128 v[188:191], v14
  v_mfma_f32_16x16x32_bf16 v[36:39], v[48:51], v[32:35], 0
  v_mfma_f32_16x16x32_bf16 v[228:231], v[48:51], v[28:31], 0
  v_readfirstlane_b32 s101, v62
  v_mov_b32 v25, s59
  v_mov_b32 v27, s59
  v_and_b32 v13, 1, v2
  v_cmp_eq_u32 vcc, 1, v13
  s_nop 2
  v_mul_f32 v36, v36, v52
  v_mul_f32 v38, v37, v53
  v_mov_b32 v37, s59
  v_mov_b32 v39, s59
  v_xor_b32 v62, 32, v57
  v_mul_f32 v228, v228, v52
  v_mul_f32 v230, v229, v53
  v_mov_b32 v229, s59
  v_mov_b32 v231, s59
  s_waitcnt lgkmcnt(0)
  s_cmp_lg_u32 s52, 6
  s_cbranch_scc1 L_nomlp
  buffer_load_dwordx4 v[40:43], v56, s[48:51], s93 offen sc1
  buffer_load_dwordx4 v[44:47], v56, s[48:51], s92 offen sc1
L_nomlp:
  s_add_u32 s3, s89, 0
  s_and_b32 s3, s3, 15
  s_lshl_b32 s3, s3, 13
  v_add_u32 v224, s3, v12
  s_add_u32 s3, s89, 1
  s_and_b32 s3, s3, 15
  s_lshl_b32 s3, s3, 13
  v_add_u32 v225, s3, v12
  s_add_u32 s3, s89, 2
  s_and_b32 s3, s3, 15
  s_lshl_b32 s3, s3, 13
  v_add_u32 v226, s3, v12
  s_add_u32 s3, s89, 3
  s_and_b32 s3, s3, 15
  s_lshl_b32 s3, s3, 13
  v_add_u32 v227, s3, v12
  ds_read_b64_tr_b16 v[192:193], v224
  ds_read_b64_tr_b16 v[194:195], v224 offset:4096
  ds_read_b64_tr_b16 v[196:197], v225
  ds_read_b64_tr_b16 v[198:199], v225 offset:4096
  ds_read_b64_tr_b16 v[200:201], v226
  ds_read_b64_tr_b16 v[202:203], v226 offset:4096
  ds_read_b64_tr_b16 v[204:205], v227
  ds_read_b64_tr_b16 v[206:207], v227 offset:4096
  s_waitcnt lgkmcnt(6)
  v_mfma_f32_16x16x32_bf16 v[16:19], v[192:195], v[128:131], 0
  s_waitcnt lgkmcnt(4)
  v_mfma_f32_16x16x32_bf16 v[16:19], v[196:199], v[132:135], v[16:19]
  s_waitcnt lgkmcnt(2)
  v_mfma_f32_16x16x32_bf16 v[16:19], v[200:203], v[136:139], v[16:19]
  s_waitcnt lgkmcnt(0)
  v_mfma_f32_16x16x32_bf16 v[16:19], v[204:207], v[140:143], v[16:19]
  s_add_u32 s3, s89, 4
  s_and_b32 s3, s3, 15
  s_lshl_b32 s3, s3, 13
  v_add_u32 v224, s3, v12
  s_add_u32 s3, s89, 5
  s_and_b32 s3, s3, 15
  s_lshl_b32 s3, s3, 13
  v_add_u32 v225, s3, v12
  s_add_u32 s3, s89, 6
  s_and_b32 s3, s3, 15
  s_lshl_b32 s3, s3, 13
  v_add_u32 v226, s3, v12
  s_add_u32 s3, s89, 7
  s_and_b32 s3, s3, 15
  s_lshl_b32 s3, s3, 13
  v_add_u32 v227, s3, v12
  ds_read_b64_tr_b16 v[208:209], v224
  ds_read_b64_tr_b16 v[210:211], v224 offset:4096
  ds_read_b64_tr_b16 v[212:213], v225
  ds_read_b64_tr_b16 v[214:215], v225 offset:4096
  ds_read_b64_tr_b16 v[216:217], v226
  ds_read_b64_tr_b16 v[218:219], v226 offset:4096
  ds_read_b64_tr_b16 v[220:221], v227
  ds_read_b64_tr_b16 v[222:223], v227 offset:4096
  s_waitcnt lgkmcnt(6)
  v_mfma_f32_16x16x32_bf16 v[16:19], v[208:211], v[144:147], v[16:19]
  s_waitcnt lgkmcnt(4)
  v_mfma_f32_16x16x32_bf16 v[16:19], v[212:215], v[148:151], v[16:19]
  s_waitcnt lgkmcnt(2)
  v_mfma_f32_16x16x32_bf16 v[16:19], v[216:219], v[152:155], v[16:19]
  s_waitcnt lgkmcnt(0)
  v_mfma_f32_16x16x32_bf16 v[16:19], v[220:223], v[156:159], v[16:19]
  s_barrier
  s_add_u32 s3, s89, 8
  s_and_b32 s3, s3, 15
  s_lshl_b32 s3, s3, 13
  v_add_u32 v224, s3, v12
  s_add_u32 s3, s89, 9
  s_and_b32 s3, s3, 15
  s_lshl_b32 s3, s3, 13
  v_add_u32 v225, s3, v12
  s_add_u32 s3, s89, 10
  s_and_b32 s3, s3, 15
  s_lshl_b32 s3, s3, 13
  v_add_u32 v226, s3, v12
  s_add_u32 s3, s89, 11
  s_and_b32 s3, s3, 15
  s_lshl_b32 s3, s3, 13
  v_add_u32 v227, s3, v12
  ds_read_b64_tr_b16 v[192:193], v224
  ds_read_b64_tr_b16 v[194:195], v224 offset:4096
  ds_read_b64_tr_b16 v[196:197], v225
  ds_read_b64_tr_b16 v[198:199], v225 offset:4096
  ds_read_b64_tr_b16 v[200:201], v226
  ds_read_b64_tr_b16 v[202:203], v226 offset:4096
  ds_read_b64_tr_b16 v[204:205], v227
  ds_read_b64_tr_b16 v[206:207], v227 offset:4096
  s_waitcnt lgkmcnt(6)
  v_mfma_f32_16x16x32_bf16 v[16:19], v[192:195], v[160:163], v[16:19]
  s_waitcnt lgkmcnt(4)
  v_mfma_f32_16x16x32_bf16 v[16:19], v[196:199], v[164:167], v[16:19]
  s_waitcnt lgkmcnt(2)
  v_mfma_f32_16x16x32_bf16 v[16:19], v[200:203], v[168:171], v[16:19]
  s_waitcnt lgkmcnt(0)
  v_mfma_f32_16x16x32_bf16 v[16:19], v[204:207], v[172:175], v[16:19]
  s_cmp_lg_u32 s52, 6
  s_cbranch_scc1 L_nomlc
  v_lshrrev_b32 v13, 5, v1
  v_lshlrev_b32 v13, 2, v13
  v_add_u32 v13, 0x27580, v13
  ds_read_b32 v48, v13
  ds_read_b32 v49, v13 offset:8
  s_waitcnt vmcnt(0)
L_mlchk:
  v_min3_u32 v13, v41, v43, v45
  v_max3_u32 v14, v41, v43, v45
  v_min_u32 v13, v13, v47
  v_max_u32 v14, v14, v47
  v_cmp_ne_u32 vcc, s59, v13
  v_cmp_ne_u32 s[62:63], s59, v14
  s_or_b64 vcc, vcc, s[62:63]
  s_cbranch_vccz L_mlok
  s_sub_u32 s61, s61, 1
  s_cbranch_scc1 L_end
  buffer_load_dwordx4 v[40:43], v56, s[48:51], s93 offen sc1
  buffer_load_dwordx4 v[44:47], v56, s[48:51], s92 offen sc1
  s_waitcnt vmcnt(0)
  s_branch L_mlchk
L_mlok:
  v_mov_b32 v50, v40
  v_mov_b32 v51, v44
  s_nop 0
  v_max_f32_dpp v50, v50, v50 row_ror:4 row_mask:0xf bank_mask:0xf
  v_max_f32_dpp v51, v51, v51 row_ror:4 row_mask:0xf bank_mask:0xf
  s_nop 0
  v_max_f32_dpp v50, v50, v50 row_ror:8 row_mask:0xf bank_mask:0xf
  v_max_f32_dpp v51, v51, v51 row_ror:8 row_mask:0xf bank_mask:0xf
  s_nop 0
  v_mov_b32 v52, v50
  v_mov_b32 v53, v51
  s_nop 0
  v_permlane16_swap_b32 v50, v52
  v_permlane16_swap_b32 v51, v53
  s_nop 0
  v_max_f32 v50, v50, v52
  v_max_f32 v51, v51, v53
  v_sub_f32 v40, v40, v50
  v_sub_f32 v44, v44, v51
  v_mul_f32 v40, s94, v40
  v_mul_f32 v44, s94, v44
  v_exp_f32 v40, v40
  v_exp_f32 v44, v44
  s_nop 0
  v_mul_f32 v42, v42, v40
  v_mul_f32 v46, v46, v44
  s_nop 0
  v_add_f32_dpp v42, v42, v42 row_ror:4 row_mask:0xf bank_mask:0xf
  v_add_f32_dpp v46, v46, v46 row_ror:4 row_mask:0xf bank_mask:0xf
  s_nop 0
  v_add_f32_dpp v42, v42, v42 row_ror:8 row_mask:0xf bank_mask:0xf
  v_add_f32_dpp v46, v46, v46 row_ror:8 row_mask:0xf bank_mask:0xf
  s_nop 0
  v_mov_b32 v52, v42
  v_mov_b32 v53, v46
  s_nop 0
  v_permlane16_swap_b32 v42, v52
  v_permlane16_swap_b32 v46, v53
  s_nop 0
  v_add_f32 v42, v42, v52
  v_add_f32 v46, v46, v53
  v_rcp_f32 v42, v42
  v_rcp_f32 v46, v46
  s_waitcnt lgkmcnt(0)
  v_mul_f32 v40, v40, v48
  v_mul_f32 v44, v44, v49
  v_mul_f32 v40, v40, v42
  v_mul_f32 v44, v44, v46
  v_lshlrev_b32 v13, 2, v1
  v_add_u32 v13, 0x27800, v13
  ds_write_b32 v13, v40
  ds_write_b32 v13, v44 offset:256
  s_waitcnt lgkmcnt(0)
L_nomlc:
L_b3:
  s_add_u32 s3, s89, 12
  s_and_b32 s3, s3, 15
  s_lshl_b32 s3, s3, 13
  v_add_u32 v224, s3, v12
  s_add_u32 s3, s89, 13
  s_and_b32 s3, s3, 15
  s_lshl_b32 s3, s3, 13
  v_add_u32 v225, s3, v12
  s_add_u32 s3, s89, 14
  s_and_b32 s3, s3, 15
  s_lshl_b32 s3, s3, 13
  v_add_u32 v226, s3, v12
  s_add_u32 s3, s89, 15
  s_and_b32 s3, s3, 15
  s_lshl_b32 s3, s3, 13
  v_add_u32 v227, s3, v12
L_b3b:
  s_barrier
  ds_read_b64_tr_b16 v[208:209], v224
  ds_read_b64_tr_b16 v[210:211], v224 offset:4096
  ds_read_b64_tr_b16 v[212:213], v225
  ds_read_b64_tr_b16 v[214:215], v225 offset:4096
  ds_read_b64_tr_b16 v[216:217], v226
  ds_read_b64_tr_b16 v[218:219], v226 offset:4096
  ds_read_b64_tr_b16 v[220:221], v227
  ds_read_b64_tr_b16 v[222:223], v227 offset:4096
  ds_read_b32 v32, v61
  s_waitcnt lgkmcnt(7)
  v_mfma_f32_16x16x32_bf16 v[16:19], v[208:211], v[176:179], v[16:19]
  s_waitcnt lgkmcnt(5)
  v_mfma_f32_16x16x32_bf16 v[16:19], v[212:215], v[180:183], v[16:19]
  s_waitcnt lgkmcnt(3)
  v_mfma_f32_16x16x32_bf16 v[16:19], v[216:219], v[184:187], v[16:19]
  s_waitcnt lgkmcnt(1)
  v_mfma_f32_16x16x32_bf16 v[16:19], v[220:223], v[188:191], v[16:19]
  s_mov_b32 s98, 0x000f000f
  s_mov_b32 s99, 0x000f000f
  s_cmp_eq_u32 s101, 1
  s_nop 4
  v_cvt_pk_bf16_f32 v24, v16, v17
  v_cvt_pk_bf16_f32 v26, v18, v19
  s_mov_b64 exec, s[98:99]
  s_cbranch_scc1 L_ofast
  buffer_store_dwordx4 v[24:27], v58, s[48:51], s4 offen sc1
  s_branch L_ost
L_ofast:
  buffer_store_dwordx4 v[24:27], v58, s[48:51], s4 offen
L_ost:
  s_mov_b64 exec, -1
  buffer_load_dwordx4 v[28:31], v59, s[48:51], s5 offen sc1
  s_waitcnt vmcnt(0)
L_ochk:
  v_cmp_ne_u32 vcc, s59, v29
  v_cmp_ne_u32 s[62:63], s59, v31
  s_or_b64 vcc, vcc, s[62:63]
  s_cbranch_vccz L_ook
  s_sub_u32 s61, s61, 1
  s_cbranch_scc1 L_end
  buffer_load_dwordx4 v[28:31], v59, s[48:51], s5 offen sc1
  s_waitcnt vmcnt(0)
  s_branch L_ochk
L_ook:
  v_lshlrev_b32 v40, 16, v28
  v_and_b32 v41, 0xffff0000, v28
  v_lshlrev_b32 v42, 16, v30
  v_and_b32 v43, 0xffff0000, v30
  s_waitcnt lgkmcnt(0)
  v_mul_f32 v40, v40, v32
  v_mul_f32 v41, v41, v32
  v_mul_f32 v42, v42, v32
  v_mul_f32 v43, v43, v32
  v_cvt_pk_bf16_f32 v40, v40, v41
  v_cvt_pk_bf16_f32 v41, v42, v43
  ds_write_b64 v60, v[40:41]
  s_waitcnt lgkmcnt(0)
  s_barrier
  s_cmp_ge_u32 s52, 4
  s_cbranch_scc1 L_notSC
  ds_read_b64_tr_b16 v[48:49], v57 offset:0
  ds_read_b64_tr_b16 v[50:51], v57 offset:4096
  ds_read_b128 v[192:195], v54
  ds_read_b128 v[200:203], v54 offset:2048
  ds_read_b64_tr_b16 v[216:217], v62 offset:0
  ds_read_b64_tr_b16 v[218:219], v62 offset:4096
  ds_read_b64_tr_b16 v[44:45], v57 offset:8192
  ds_read_b64_tr_b16 v[46:47], v57 offset:12288
  ds_read_b128 v[196:199], v55
  ds_read_b128 v[204:207], v55 offset:2048
  ds_read_b64_tr_b16 v[220:221], v62 offset:8192
  ds_read_b64_tr_b16 v[222:223], v62 offset:12288
  s_waitcnt lgkmcnt(9)
  v_mfma_f32_16x16x32_bf16 v[16:19], v[192:195], v[48:51], 0
  s_waitcnt lgkmcnt(8)
  v_mfma_f32_16x16x32_bf16 v[20:23], v[200:203], v[48:51], 0
  s_waitcnt lgkmcnt(6)
  v_mfma_f32_16x16x32_bf16 v[208:211], v[192:195], v[216:219], 0
  v_mfma_f32_16x16x32_bf16 v[212:215], v[200:203], v[216:219], 0
  s_waitcnt lgkmcnt(3)
  v_mfma_f32_16x16x32_bf16 v[16:19], v[196:199], v[44:47], v[16:19]
  s_waitcnt lgkmcnt(2)
  v_mfma_f32_16x16x32_bf16 v[20:23], v[204:207], v[44:47], v[20:23]
  s_waitcnt lgkmcnt(0)
  v_mfma_f32_16x16x32_bf16 v[208:211], v[196:199], v[220:223], v[208:211]
  v_mfma_f32_16x16x32_bf16 v[212:215], v[204:207], v[220:223], v[212:215]
  s_nop 3
  s_mov_b32 s98, 0x0000ffff
  s_mov_b32 s99, 0x0000ffff
  v_add_f32 v16, v16, v17
  v_add_f32 v18, v18, v19
  v_add_f32 v20, v20, v21
  v_add_f32 v22, v22, v23
  v_add_f32 v16, v16, v18
  v_add_f32 v20, v20, v22
  v_add_f32 v36, v36, v16
  v_add_f32 v38, v38, v20
  v_mov_b32 v17, v16
  v_mov_b32 v21, v20
  s_nop 0
  v_permlane16_swap_b32 v16, v17
  v_permlane16_swap_b32 v20, v21
  v_add_f32 v36, v36, v17
  v_add_f32 v38, v38, v21
  s_mov_b64 exec, s[98:99]
  buffer_store_dwordx4 v[36:39], v63, s[48:51], s7 offen sc1
  s_mov_b64 exec, -1
  v_add_f32 v208, v208, v209
  v_add_f32 v210, v210, v211
  v_add_f32 v212, v212, v213
  v_add_f32 v214, v214, v215
  v_add_f32 v208, v208, v210
  v_add_f32 v212, v212, v214
  v_add_f32 v228, v228, v208
  v_add_f32 v230, v230, v212
  v_mov_b32 v209, v208
  v_mov_b32 v213, v212
  s_nop 0
  v_permlane16_swap_b32 v208, v209
  v_permlane16_swap_b32 v212, v213
  v_add_f32 v228, v228, v209
  v_add_f32 v230, v230, v213
  s_mov_b64 exec, s[98:99]
  buffer_store_dwordx4 v[228:231], v63, s[48:51], s6 offen sc1
  s_mov_b64 exec, -1
  s_branch L_fin
L_notSC:
  s_cmp_ge_u32 s2, 128
  s_cbranch_scc1 L_fin
  s_lshl_b32 s3, s2, 13
  s_sub_u32 s93, s52, 4
  s_lshl_b32 s92, s93, 11
  s_add_u32 s92, s92, s3
  s_add_u32 s92, s92, 0x100000
  buffer_load_dwordx4 v[128:131], v10, s[48:51], s92 offen sc1
  buffer_load_dwordx4 v[132:135], v10, s[48:51], s92 offen offset:1024 sc1
  v_and_b32 v15, 7, v1
  v_lshlrev_b32 v15, 4, v15
  s_lshl_b32 s3, s93, 7
  s_add_u32 s3, s3, 0x27a00
  v_add_u32 v15, s3, v15
  s_lshr_b32 s3, s2, 6
  s_lshl_b32 s3, s3, 10
  s_and_b32 s4, s2, 63
  s_lshl_b32 s4, s4, 4
  s_add_u32 s4, s3, s4
  v_and_b32 v18, 6, v1
  v_lshlrev_b32 v18, 1, v18
  v_lshrrev_b32 v19, 3, v1
  v_and_b32 v19, 1, v19
  v_cmp_eq_u32 s[6:7], 1, v19
  v_lshl_add_u32 v18, v19, 11, v18
  v_and_b32 v19, 31, v1
  v_lshlrev_b32 v19, 4, v19
  v_add_u32 v19, 0x27a00, v19
  v_mov_b32 v46, 1
  s_sleep 4
  buffer_load_dwordx4 v[136:139], v10, s[48:51], s92 offen sc1
  buffer_load_dwordx4 v[140:143], v10, s[48:51], s92 offen offset:1024 sc1
L_fpoll:
  s_waitcnt vmcnt(2)
  v_min3_u32 v13, v129, v131, v133
  v_max3_u32 v14, v129, v131, v133
  v_min_u32 v13, v13, v135
  v_max_u32 v14, v14, v135
  v_cmp_ne_u32 vcc, s59, v13
  v_cmp_ne_u32 s[62:63], s59, v14
  s_or_b64 vcc, vcc, s[62:63]
  s_cbranch_vccz L_fokA
  buffer_load_dwordx4 v[128:131], v10, s[48:51], s92 offen sc1
  buffer_load_dwordx4 v[132:135], v10, s[48:51], s92 offen offset:1024 sc1
  s_waitcnt vmcnt(2)
  v_min3_u32 v13, v137, v139, v141
  v_max3_u32 v14, v137, v139, v141
  v_min_u32 v13, v13, v143
  v_max_u32 v14, v14, v143
  v_cmp_ne_u32 vcc, s59, v13
  v_cmp_ne_u32 s[62:63], s59, v14
  s_or_b64 vcc, vcc, s[62:63]
  s_cbranch_vccz L_fokB
  buffer_load_dwordx4 v[136:139], v10, s[48:51], s92 offen sc1
  buffer_load_dwordx4 v[140:143], v10, s[48:51], s92 offen offset:1024 sc1
  s_sub_u32 s61, s61, 1
  s_cbranch_scc1 L_end
  s_branch L_fpoll
L_fokB:
  v_add_f32 v44, v136, v140
  v_add_f32 v45, v138, v142
  s_branch L_fok
L_fokA:
  v_add_f32 v44, v128, v132
  v_add_f32 v45, v130, v134
L_fok:
  s_nop 0
  v_add_f32_dpp v44, v44, v44 row_ror:8 row_mask:0xf bank_mask:0xf
  v_add_f32_dpp v45, v45, v45 row_ror:8 row_mask:0xf bank_mask:0xf
  v_mov_b32 v40, v44
  v_mov_b32 v41, v45
  s_nop 0
  v_permlane16_swap_b32 v44, v40
  v_permlane16_swap_b32 v45, v41
  v_add_f32 v44, v44, v40
  v_add_f32 v45, v45, v41
  v_mov_b32 v40, v44
  v_mov_b32 v41, v45
  s_nop 0
  v_permlane32_swap_b32 v44, v40
  v_permlane32_swap_b32 v45, v41
  v_add_f32 v44, v44, v40
  v_add_f32 v45, v45, v41
  s_mov_b64 exec, 0xff
  ds_write_b96 v15, v[44:46]
  s_mov_b64 exec, -1
  s_cmp_lg_u32 s52, 7
  s_cbranch_scc1 L_fin
L_rspin:
  ds_read_b96 v[40:42], v19
  s_waitcnt lgkmcnt(0)
  v_cmp_ne_u32 vcc, 1, v42
  s_cbranch_vccz L_rok
  s_sub_u32 s61, s61, 1
  s_cbranch_scc1 L_end
  s_branch L_rspin
L_rok:
  v_add_f32_dpp v40, v40, v40 row_ror:8 row_mask:0xf bank_mask:0xf
  v_add_f32_dpp v41, v41, v41 row_ror:8 row_mask:0xf bank_mask:0xf
  v_mov_b32 v44, v40
  v_mov_b32 v45, v41
  s_nop 0
  v_permlane16_swap_b32 v40, v44
  v_permlane16_swap_b32 v41, v45
  v_add_f32 v40, v40, v44
  v_add_f32 v41, v41, v45
  v_cndmask_b32 v40, v40, v41, s[6:7]
  s_nop 1
  v_mov_b32_dpp v41, v40 quad_perm:[1,0,3,2] row_mask:0xf bank_mask:0xf
  v_cvt_pk_bf16_f32 v40, v40, v41
  s_mov_b64 exec, 0x5555
  buffer_store_dword v40, v18, s[44:47], s4 offen
  s_cmp_lg_u32 s2, 0
  s_cbranch_scc1 L_fin
  s_mov_b64 exec, 1
  v_mov_b32 v41, s59
  v_mov_b32 v42, 0
  buffer_store_dword v41, v42, s[48:51], 0 offen sc1
L_fin:
L_end:
  s_endpgm
.section .rodata,"a"
.p2align 6
.amdhsa_kernel gated_mix__gqa_block_cached__glu_gated_glu__decode_kernel
  .amdhsa_next_free_vgpr 256
  .amdhsa_next_free_sgpr 102
  .amdhsa_accum_offset 256
  .amdhsa_group_segment_fixed_size 0
  .amdhsa_kernarg_size 104
  .amdhsa_user_sgpr_count 2
  .amdhsa_user_sgpr_kernarg_segment_ptr 1
  .amdhsa_system_sgpr_workgroup_id_x 1
.end_amdhsa_kernel
```
